```python
import torch

def _softmax(x, axis=-1):
    return torch.softmax(x, dim=axis)
def _gelu(x):
    return torch.nn.functional.gelu(x, approximate="tanh")
def _silu(x):
    return torch.nn.functional.silu(x)
def _sigmoid(x):
    return torch.sigmoid(x)
def _layernorm(x, axis=-1, eps=1e-5):
    m = x.mean(dim=axis, keepdim=True)
    v = x.var(dim=axis, keepdim=True, unbiased=False)
    return (x - m) / torch.sqrt(v + eps)
def _scatter_add(tgt, idx, src, axis=0):
    return tgt.clone().index_add_(axis, idx, src)
def _segment_sum(src, seg, n):
    out = torch.zeros((n,) + src.shape[1:], dtype=src.dtype)
    return out.index_add_(0, seg, src)
def _pad(x, pw):
    flat = tuple(v for pair in reversed(pw) for v in pair)
    return torch.nn.functional.pad(x, flat)

kernel_name = 'interleave_layers__linear_kernel_hedgehog__spectral_fnet__prompt'

def setup_inputs():

    _w = (lambda a: (lambda t: t.to(torch.bfloat16) if t.is_floating_point() else t)(torch.as_tensor(a)))
    def _A_setup():
        B, S, D, H = 1, 2048, 448, 16
        Dh = D // H
        return {
            "x": _w((lambda *s: torch.randn(*s, dtype=torch.bfloat16) * 0.4)(B, S, D)),
            "wqkv": _w((lambda *s: torch.randn(*s, dtype=torch.bfloat16) * 1.6)(D, 3 * D)),
            "w_phi": _w((lambda *s: torch.randn(*s, dtype=torch.bfloat16) * 1.6)(H, Dh, Dh) * (Dh ** -0.5)),
            "wo": _w((lambda *s: torch.randn(*s, dtype=torch.bfloat16) * 1.6)(D, D)),
        }
    _A_in = _A_setup()

    def _B_setup():
        B, S, D = 1, 2048, 448
        ns = torch.arange(S)[:, None] * torch.arange(S)[None, :]
        nd = torch.arange(D)[:, None] * torch.arange(D)[None, :]
        Ws_re = torch.cos(-2.0 * torch.pi * ns / S).to(float)
        Ws_im = torch.sin(-2.0 * torch.pi * ns / S).to(float)
        Wd_re = torch.cos(-2.0 * torch.pi * nd / D).to(float)
        Wd_im = torch.sin(-2.0 * torch.pi * nd / D).to(float)
        return {
            "x": _w((lambda *s: torch.randn(*s, dtype=torch.bfloat16) * 0.4)(B, S, D)),
            "dft_seq_re": _w(Ws_re),
            "dft_seq_im": _w(Ws_im),
            "dft_hid_re": _w(Wd_re),
            "dft_hid_im": _w(Wd_im),
        }
    _B_in = _B_setup()

    return {
        "A_x": _A_in["x"],
        "A_wqkv": _A_in["wqkv"],
        "A_w_phi": _A_in["w_phi"],
        "A_wo": _A_in["wo"],
        "B_x": _B_in["x"],
        "B_dft_seq_re": _B_in["dft_seq_re"],
        "B_dft_seq_im": _B_in["dft_seq_im"],
        "B_dft_hid_re": _B_in["dft_hid_re"],
        "B_dft_hid_im": _B_in["dft_hid_im"],
    }

def reference(A_x, A_wqkv, A_w_phi, A_wo, B_x, B_dft_seq_re, B_dft_seq_im, B_dft_hid_re, B_dft_hid_im):
    def _A_ref(x, wqkv, w_phi, wo):
        B, S, D = x.shape
        H = 16; Dh = D // H
        qkv = (lambda x, *d: x.permute(*d))((x @ wqkv).reshape(B, S, 3, H, Dh), 2, 0, 3, 1, 4)
        q, k, v = qkv[0], qkv[1], qkv[2]
        pq = torch.einsum("bhsd,hdf->bhsf", q, w_phi)
        pk = torch.einsum("bhsd,hdf->bhsf", k, w_phi)
        phi_q = torch.concatenate([_softmax(pq, axis=-1), _softmax(-pq, axis=-1)], axis=-1)
        phi_k = torch.concatenate([_softmax(pk, axis=-1), _softmax(-pk, axis=-1)], axis=-1)
        kv = torch.einsum("bhsf,bhsd->bhfd", phi_k, v)
        z  = torch.einsum("bhsf->bhf", phi_k)
        num = torch.einsum("bhqf,bhfd->bhqd", phi_q, kv)
        den = torch.einsum("bhqf,bhf->bhq", phi_q, z)[..., None] + 1e-6
        o = num / den
        return (lambda x, *d: x.permute(*d))(o, 0, 2, 1, 3).reshape(B, S, D) @ wo

    def _B_ref(x, dft_seq_re, dft_seq_im, dft_hid_re, dft_hid_im):
        a = torch.einsum("bsd,ed->bse", x, dft_hid_re)
        b = torch.einsum("bsd,ed->bse", x, dft_hid_im)
        y = torch.einsum("ts,bse->bte", dft_seq_re, a) - torch.einsum("ts,bse->bte", dft_seq_im, b)
        return y

    x = A_x
    x = x + _A_ref(_layernorm(x, axis=-1), A_wqkv, A_w_phi, A_wo)
    x = x + _B_ref(_layernorm(x, axis=-1), B_dft_seq_re, B_dft_seq_im, B_dft_hid_re, B_dft_hid_im)
    x = x + _A_ref(_layernorm(x, axis=-1), A_wqkv, A_w_phi, A_wo)
    x = x + _B_ref(_layernorm(x, axis=-1), B_dft_seq_re, B_dft_seq_im, B_dft_hid_re, B_dft_hid_im)
    return x
```

```asm
; @launch grid=(256,1,1) block=(256,1,1) lds=162048
.amdgcn_target "amdgcn-amd-amdhsa--gfx950"
.text
.globl interleave_layers__linear_kernel_hedgehog__spectral_fnet__prompt_kernel
.p2align 8
.type interleave_layers__linear_kernel_hedgehog__spectral_fnet__prompt_kernel,@function
interleave_layers__linear_kernel_hedgehog__spectral_fnet__prompt_kernel:
    s_cmp_ge_u32 s2, 256
    s_cbranch_scc1 L_m_end_1
    s_load_dwordx2 s[4:5], s[0:1], 88
    s_load_dwordx4 s[24:27], s[0:1], 0
    s_load_dwordx4 s[36:39], s[0:1], 16
    s_getpc_b64 s[12:13]
L_pc:
    s_lshr_b32 s14, s2, 3
    s_lshl_b32 s14, s14, 10
    v_lshrrev_b32 v2, 5, v0
    v_lshl_add_u32 v2, v2, 7, s14
    v_min_u32 v2, L_codeend-L_pc-4, v2
    global_load_dword v255, v2, s[12:13]
    s_mov_b32 s40, 1
    v_lshrrev_b32 v2, 6, v0
    v_and_b32 v1, 63, v0
    v_readfirstlane_b32 s10, v2
    s_and_b32 s9, s2, 7
    s_lshl_b32 s9, s9, 1
    s_bfe_u32 s12, s2, 0x10003
    s_add_u32 s9, s9, s12
    s_lshr_b32 s8, s2, 4
    s_lshl_b32 s11, s9, 2
    s_add_u32 s11, s11, s10
    v_lshlrev_b32 v2, 4, v1
    s_sub_u32 s12, 32, s9
    s_cmp_eq_u32 s9, 0
    s_cselect_b32 s12, 16, s12
    s_cmp_lt_u32 s10, 2
    s_cselect_b32 s12, s9, s12
    s_and_b32 s45, s10, 1
    s_lshl_b32 s45, s45, 5
    s_add_u32 s45, s45, s12
    s_cmp_lt_u32 s8, 14
    s_cselect_b32 s18, 0, 2147418112
    s_min_u32 s19, s8, 13
    v_lshrrev_b32 v6, 2, v1
    v_and_b32 v7, 3, v1
    v_mul_u32_u24 v8, 2688, v6
    v_mul_u32_u24 v9, 14, v7
    v_min_u32 v9, 40, v9
    v_add_u32 v8, v8, v9
    s_cmp_ge_u32 s9, 14
    s_cselect_b32 s35, 2147418112, 0
    v_add_u32 v216, s35, v8
    s_min_u32 s12, s9, 13
    s_mul_i32 s12, s12, 86016
    s_mul_i32 s13, s8, 56
    s_add_u32 s47, s12, s13
    s_lshr_b32 s12, s10, 1
    s_mul_i32 s13, s12, 43008
    s_add_u32 s47, s47, s13
    s_and_b32 s13, s10, 1
    s_mul_i32 s16, s13, 896
    s_add_u32 s16, s16, s47
    s_add_u32 s16, s16, 896
    s_mul_i32 s14, s8, 86016
    s_add_u32 s14, s14, 921600
    s_lshl_b32 s12, s12, 10
    s_lshl_b32 s43, s9, 11
    s_add_u32 s12, s12, s43
    s_add_u32 s12, s12, s14
    s_mul_i32 s13, s13, 28672
    s_add_u32 s44, s12, s13
    s_mul_i32 s56, s45, 896
    v_cmp_lt_u32 vcc, 55, v1
    v_mov_b32 v11, 2147418112
    s_nop 0
    v_cndmask_b32 v11, v2, v11, vcc
    s_mul_i32 s32, s8, 114688
    s_add_u32 s32, s32, s56
    s_add_u32 s33, s32, 57344
    s_lshl_b32 s55, s11, 9
    s_add_u32 s55, s55, 7081984
    v_and_b32 v5, 31, v1
    v_lshrrev_b32 v4, 5, v1
    v_and_b32 v14, 15, v1
    v_lshlrev_b32 v13, 3, v14
    v_lshlrev_b32 v14, 7, v14
    v_lshlrev_b32 v252, 4, v5
    s_waitcnt lgkmcnt(0)
    s_load_dwordx2 s[48:49], s[4:5], 0
    s_mov_b32 s28, s26
    s_mov_b32 s29, s27
    s_mov_b32 s30, 1204224
    s_mov_b32 s31, 0x20000
    buffer_load_dwordx4 v[208:211], v216, s[28:31], s16 offen
    s_lshl_b32 s12, s8, 4
    s_lshl_b32 s13, s10, 2
    s_add_u32 s12, s12, s13
    v_add_u32 v3, s12, v7
    v_min_u32 v3, 195, v3
    v_lshlrev_b32 v3, 7, v3
    s_mul_i32 s17, s9, 25088
    s_lshl_b32 s15, s10, 10
    s_lshl_b32 s3, s10, 12
    s_add_u32 s57, s56, 457728
    s_add_u32 s58, s56, 915456
    s_add_u32 s59, s56, 1373184
    v_and_b32 v10, 7, v1
    v_lshrrev_b32 v12, 4, v1
    v_xor_b32 v10, v10, v12
    v_lshrrev_b32 v12, 3, v1
    v_mul_u32_u24 v12, 57344, v12
    v_lshl_add_u32 v242, v10, 4, v12
    v_xor_b32 v243, 64, v242
    v_bfe_u32 v15, v1, 3, 2
    s_lshl_b32 s12, s10, 2
    v_add_u32 v15, s12, v15
    v_and_b32 v12, 7, v15
    v_cmp_ne_u32 vcc, 7, v12
    s_lshr_b32 s13, s10, 1
    v_subrev_u32 v15, s13, v15
    v_mad_u32_u24 v15, v4, 14, v15
    v_mul_u32_u24 v15, 896, v15
    s_and_b32 s12, s12, 4
    v_xor_b32 v12, s12, v10
    v_lshl_add_u32 v15, v12, 4, v15
    v_mov_b32 v12, 2147418112
    v_cndmask_b32 v254, v12, v15, vcc
    v_bfe_u32 v128, v1, 3, 2
    v_and_b32 v129, 3, v1
    v_lshl_add_u32 v128, v128, 2, v129
    s_lshl_b32 s12, s8, 4
    v_add_u32 v128, s12, v128
    v_bfe_u32 v129, v1, 2, 1
    v_or_b32 v130, v128, v129
    v_cmp_eq_u32 vcc, 0, v130
    v_mov_b32 v130, 224
    s_nop 0
    v_cndmask_b32 v128, v128, v130, vcc
    v_cvt_f32_u32 v128, v128
    v_cvt_f32_u32 v129, v129
    v_mul_f32 v177, 0x3b124925, v128
    v_mul_f32 v176, 0x3e800000, v129
    v_lshrrev_b32 v130, 5, v1
    s_mul_i32 s12, s10, 7168
    s_add_u32 s12, s12, 86208
    v_add_u32 v179, s12, v2
    s_mul_i32 s12, s10, 112
    v_lshlrev_b32 v130, 3, v130
    v_add_u32 v130, s12, v130
    v_cvt_f32_u32 v130, v130
    v_fmac_f32 v176, v177, v130
    v_mul_f32 v178, 0x41800000, v177
    s_bitcmp1_b32 s10, 0
    s_cselect_b32 s12, 2147418112, 0
    v_max_u32 v216, s12, v216
    buffer_load_dwordx4 v[212:215], v216, s[28:31], s47 offen
    s_mov_b32 s26, 1835008
    s_mov_b32 s27, 0x20000
    s_mov_b32 s6, 21551104
    s_mov_b32 s7, 0x20000
    s_mov_b32 s60, s38
    s_mov_b32 s61, s39
    s_mov_b32 s62, 401408
    s_mov_b32 s63, 0x20000
    s_mov_b32 s38, 25088
    s_mov_b32 s39, 0x20000
    buffer_load_dword v0, v3, s[60:63], s17 offen
    s_and_b32 s12, s10, 1
    s_lshl_b32 s12, s12, 10
    s_add_u32 m0, s12, 160000
    s_mul_i32 s13, s8, 1568
    s_add_u32 s12, s12, s13
    buffer_load_dwordx4 v2, s[36:39], s12 offen lds
    v_mov_b32 v217, v11
    s_mov_b32 s38, s32
    s_mov_b32 s39, s33
    s_add_u32 s20, s4, 7245824
    s_addc_u32 s21, s5, 0
    s_mov_b32 s22, 6041600
    s_mov_b32 s23, 0x20000
    buffer_load_dwordx4 v[192:195], v217, s[24:27], s38 offen
    buffer_load_dwordx4 v[196:199], v217, s[24:27], s39 offen
    buffer_load_dword v0, v252, s[4:7], s55 offen sc1
    s_lshl_b32 s54, s11, 12
    s_add_u32 s54, s54, 6557696
    s_lshl_b32 s53, s8, 8
    s_add_u32 s53, s53, s54
    s_mov_b32 s50, 0
    s_lshl_b32 s12, s8, 2
    s_add_u32 s12, s12, s10
    s_lshl_b32 s46, s12, 11
    s_lshl_b32 s13, s9, 7
    s_add_u32 s46, s46, s13
    s_add_u32 s46, s46, 2889728
    s_lshl_b32 s12, s12, 4
    s_add_u32 s12, s12, s9
    s_lshl_b32 s41, s12, 10
    s_add_u32 s41, s41, 1841152
    v_bfe_u32 v10, v1, 1, 3
    v_xor_b32 v11, v10, v4
    v_lshlrev_b32 v11, 4, v11
    v_lshl_add_u32 v11, v5, 7, v11
    v_add_u32 v11, s3, v11
    v_mov_b32 v244, v11
    v_xor_b32 v245, 32, v244
    v_xor_b32 v246, 64, v244
    v_xor_b32 v247, 96, v244
    v_add_u32 v248, 143616, v11
    v_xor_b32 v249, 32, v248
    v_xor_b32 v250, 64, v248
    v_xor_b32 v251, 96, v248
    v_bfe_u32 v6, v1, 2, 2
    v_lshl_add_u32 v15, v4, 3, v6
    v_lshlrev_b32 v15, 6, v15
    v_bfe_u32 v6, v1, 4, 1
    v_lshl_add_u32 v15, v6, 5, v15
    v_lshl_add_u32 v15, v7, 3, v15
    v_lshrrev_b32 v6, 4, v1
    v_xor_b32 v10, v10, v6
    v_lshlrev_b32 v10, 4, v10
    v_add_u32 v10, v10, v14
    s_lshr_b32 s12, s10, 1
    s_lshl_b32 s12, s12, 11
    s_add_u32 s32, s12, 114880
    v_xor_b32 v11, 64, v10
    v_add_u32 v160, s32, v10
    v_add_u32 v161, s32, v11
    v_lshlrev_b32 v10, 1, v13
    v_lshl_add_u32 v162, v6, 9, v10
    s_and_b32 s33, s10, 1
    s_lshl_b32 s33, s33, 8
    s_add_u32 s12, s33, 86208
    v_add_u32 v162, s12, v162
    v_lshl_add_u32 v10, v6, 9, v10
    v_add_u32 v10, 1024, v10
    v_add_u32 v11, s33, v252
    v_cmp_eq_u32 vcc, 1, v4
    s_nop 1
    v_cndmask_b32 v10, v10, v11, vcc
    s_add_u32 s12, s18, s33
    v_add_u32 v163, s12, v10
    v_lshrrev_b32 v6, 3, v5
    v_and_b32 v10, 3, v5
    v_lshl_add_u32 v6, v6, 2, v10
    v_and_b32 v10, 4, v5
    s_lshl_b32 s12, s19, 4
    v_lshl_add_u32 v10, v10, 1, s12
    v_sub_u32 v11, 433, v10
    v_cmp_lt_u32 vcc, 7, v6
    s_nop 1
    v_cndmask_b32 v10, v10, v11, vcc
    v_add_u32 v10, v10, v6
    v_cmp_eq_u32 vcc, 448, v10
    v_mov_b32 v11, 224
    s_nop 0
    v_cndmask_b32 v10, v10, v11, vcc
    v_bfe_u32 v11, v10, 3, 3
    s_lshr_b32 s12, s33, 7
    v_lshl_add_u32 v165, v4, 2, s12
    v_xor_b32 v11, v11, v165
    v_and_b32 v165, 7, v10
    v_lshlrev_b32 v165, 1, v165
    v_lshl_add_u32 v11, v11, 4, v165
    v_lshrrev_b32 v10, 6, v10
    v_lshl_add_u32 v11, v10, 12, v11
    v_lshl_add_u32 v11, v4, 10, v11
    s_lshl_b32 s12, s33, 1
    s_add_u32 s12, s12, s32
    v_add_u32 v164, s12, v11
    v_xor_b32 v165, 16, v164
    v_bfe_u32 v10, v5, 2, 1
    v_mad_u32_u24 v10, v10, 14, v6
    v_mul_u32_u24 v11, 112, v4
    v_add_lshl_u32 v10, v10, v11, 1
    v_add_u32 v166, 160000, v10
    v_cmp_gt_u32 vcc, 14, v6
    s_nop 1
    v_cndmask_b32 v167, 0, -1, vcc
    v_lshlrev_b32 v10, 4, v4
    v_lshrrev_b32 v168, v10, v167
    s_add_u32 s14, s14, s15
    s_lshl_b32 s34, s19, 16
    s_lshl_b32 s12, s9, 12
    s_add_u32 s34, s34, s12
    s_add_u32 s34, s34, s32
    s_add_u32 s34, s34, -110784
    v_fmamk_f32 v129, v177, 0x3f800000, v176
    v_fmamk_f32 v130, v177, 0x40000000, v176
    v_fmamk_f32 v131, v177, 0x40400000, v176
    v_cos_f32 v128, v176
    v_cos_f32 v129, v129
    v_cos_f32 v130, v130
    v_cos_f32 v131, v131
    v_cvt_pk_bf16_f32 v144, v128, v129
    v_cvt_pk_bf16_f32 v145, v130, v131
    v_fmamk_f32 v132, v177, 0x40800000, v176
    v_fmamk_f32 v133, v177, 0x40a00000, v176
    v_fmamk_f32 v134, v177, 0x40c00000, v176
    v_fmamk_f32 v135, v177, 0x40e00000, v176
    v_cos_f32 v132, v132
    v_cos_f32 v133, v133
    v_cos_f32 v134, v134
    v_cos_f32 v135, v135
    v_cvt_pk_bf16_f32 v146, v132, v133
    v_cvt_pk_bf16_f32 v147, v134, v135
    ds_write_b128 v179, v[144:147] offset:0
    v_add_f32 v152, v178, v176
    v_cos_f32 v154, v178
    v_fmamk_f32 v137, v177, 0x3f800000, v152
    v_fmamk_f32 v138, v177, 0x40000000, v152
    v_fmamk_f32 v139, v177, 0x40400000, v152
    v_cos_f32 v136, v152
    v_cos_f32 v137, v137
    v_cos_f32 v138, v138
    v_cos_f32 v139, v139
    v_cvt_pk_bf16_f32 v148, v136, v137
    v_cvt_pk_bf16_f32 v149, v138, v139
    v_fmamk_f32 v140, v177, 0x40800000, v152
    v_fmamk_f32 v141, v177, 0x40a00000, v152
    v_fmamk_f32 v142, v177, 0x40c00000, v152
    v_fmamk_f32 v143, v177, 0x40e00000, v152
    v_cos_f32 v140, v140
    v_cos_f32 v141, v141
    v_cos_f32 v142, v142
    v_cos_f32 v143, v143
    v_add_f32 v154, v154, v154
    v_cvt_pk_bf16_f32 v150, v140, v141
    v_cvt_pk_bf16_f32 v151, v142, v143
    ds_write_b128 v179, v[148:151] offset:1024
    s_add_u32 m0, s15, 114880
    s_add_u32 s12, s17, 0
    buffer_load_dwordx4 v254, s[60:63], s12 offen lds
    v_pk_fma_f32 v[128:129], v[136:137], v[154:155], v[128:129] op_sel_hi:[1,0,1] neg_lo:[0,0,1] neg_hi:[0,0,1]
    v_pk_fma_f32 v[130:131], v[138:139], v[154:155], v[130:131] op_sel_hi:[1,0,1] neg_lo:[0,0,1] neg_hi:[0,0,1]
    v_pk_fma_f32 v[132:133], v[140:141], v[154:155], v[132:133] op_sel_hi:[1,0,1] neg_lo:[0,0,1] neg_hi:[0,0,1]
    v_pk_fma_f32 v[134:135], v[142:143], v[154:155], v[134:135] op_sel_hi:[1,0,1] neg_lo:[0,0,1] neg_hi:[0,0,1]
    v_cvt_pk_bf16_f32 v144, v128, v129
    v_cvt_pk_bf16_f32 v145, v130, v131
    v_cvt_pk_bf16_f32 v146, v132, v133
    v_cvt_pk_bf16_f32 v147, v134, v135
    ds_write_b128 v179, v[144:147] offset:2048
    s_add_u32 m0, s15, 118976
    s_add_u32 s12, s17, 128
    buffer_load_dwordx4 v254, s[60:63], s12 offen lds
    v_pk_fma_f32 v[136:137], v[128:129], v[154:155], v[136:137] op_sel_hi:[1,0,1] neg_lo:[0,0,1] neg_hi:[0,0,1]
    v_pk_fma_f32 v[138:139], v[130:131], v[154:155], v[138:139] op_sel_hi:[1,0,1] neg_lo:[0,0,1] neg_hi:[0,0,1]
    v_pk_fma_f32 v[140:141], v[132:133], v[154:155], v[140:141] op_sel_hi:[1,0,1] neg_lo:[0,0,1] neg_hi:[0,0,1]
    v_pk_fma_f32 v[142:143], v[134:135], v[154:155], v[142:143] op_sel_hi:[1,0,1] neg_lo:[0,0,1] neg_hi:[0,0,1]
    v_cvt_pk_bf16_f32 v148, v136, v137
    v_cvt_pk_bf16_f32 v149, v138, v139
    v_cvt_pk_bf16_f32 v150, v140, v141
    v_cvt_pk_bf16_f32 v151, v142, v143
    ds_write_b128 v179, v[148:151] offset:3072
    s_add_u32 m0, s15, 123072
    s_add_u32 s12, s17, 256
    buffer_load_dwordx4 v254, s[60:63], s12 offen lds
    v_pk_fma_f32 v[128:129], v[136:137], v[154:155], v[128:129] op_sel_hi:[1,0,1] neg_lo:[0,0,1] neg_hi:[0,0,1]
    v_pk_fma_f32 v[130:131], v[138:139], v[154:155], v[130:131] op_sel_hi:[1,0,1] neg_lo:[0,0,1] neg_hi:[0,0,1]
    v_pk_fma_f32 v[132:133], v[140:141], v[154:155], v[132:133] op_sel_hi:[1,0,1] neg_lo:[0,0,1] neg_hi:[0,0,1]
    v_pk_fma_f32 v[134:135], v[142:143], v[154:155], v[134:135] op_sel_hi:[1,0,1] neg_lo:[0,0,1] neg_hi:[0,0,1]
    v_cvt_pk_bf16_f32 v144, v128, v129
    v_cvt_pk_bf16_f32 v145, v130, v131
    v_cvt_pk_bf16_f32 v146, v132, v133
    v_cvt_pk_bf16_f32 v147, v134, v135
    ds_write_b128 v179, v[144:147] offset:4096
    s_add_u32 m0, s15, 127168
    s_add_u32 s12, s17, 384
    buffer_load_dwordx4 v254, s[60:63], s12 offen lds
    v_pk_fma_f32 v[136:137], v[128:129], v[154:155], v[136:137] op_sel_hi:[1,0,1] neg_lo:[0,0,1] neg_hi:[0,0,1]
    v_pk_fma_f32 v[138:139], v[130:131], v[154:155], v[138:139] op_sel_hi:[1,0,1] neg_lo:[0,0,1] neg_hi:[0,0,1]
    v_pk_fma_f32 v[140:141], v[132:133], v[154:155], v[140:141] op_sel_hi:[1,0,1] neg_lo:[0,0,1] neg_hi:[0,0,1]
    v_pk_fma_f32 v[142:143], v[134:135], v[154:155], v[142:143] op_sel_hi:[1,0,1] neg_lo:[0,0,1] neg_hi:[0,0,1]
    v_cvt_pk_bf16_f32 v148, v136, v137
    v_cvt_pk_bf16_f32 v149, v138, v139
    v_cvt_pk_bf16_f32 v150, v140, v141
    v_cvt_pk_bf16_f32 v151, v142, v143
    ds_write_b128 v179, v[148:151] offset:5120
    s_add_u32 m0, s15, 131264
    s_add_u32 s12, s17, 512
    buffer_load_dwordx4 v254, s[60:63], s12 offen lds
    v_pk_fma_f32 v[128:129], v[136:137], v[154:155], v[128:129] op_sel_hi:[1,0,1] neg_lo:[0,0,1] neg_hi:[0,0,1]
    v_pk_fma_f32 v[130:131], v[138:139], v[154:155], v[130:131] op_sel_hi:[1,0,1] neg_lo:[0,0,1] neg_hi:[0,0,1]
    v_pk_fma_f32 v[132:133], v[140:141], v[154:155], v[132:133] op_sel_hi:[1,0,1] neg_lo:[0,0,1] neg_hi:[0,0,1]
    v_pk_fma_f32 v[134:135], v[142:143], v[154:155], v[134:135] op_sel_hi:[1,0,1] neg_lo:[0,0,1] neg_hi:[0,0,1]
    v_cvt_pk_bf16_f32 v144, v128, v129
    v_cvt_pk_bf16_f32 v145, v130, v131
    v_cvt_pk_bf16_f32 v146, v132, v133
    v_cvt_pk_bf16_f32 v147, v134, v135
    ds_write_b128 v179, v[144:147] offset:6144
    s_add_u32 m0, s15, 135360
    s_add_u32 s12, s17, 640
    buffer_load_dwordx4 v254, s[60:63], s12 offen lds
    s_add_u32 m0, s15, 139456
    s_add_u32 s12, s17, 768
    buffer_load_dwordx4 v254, s[60:63], s12 offen lds
    s_getreg_b32 s12, hwreg(HW_REG_XCC_ID, 0, 4)
    s_waitcnt lgkmcnt(0)
    s_add_u32 s48, s48, 2135587861
    s_addc_u32 s49, s49, 2654435769
    s_and_b32 s48, s48, 0xfffffff0
    s_and_b32 s12, s12, 15
    s_or_b32 s42, s48, s12
    s_mov_b32 s43, s49
    v_mov_b32 v8, s48
    v_mov_b32 v9, s49
    v_cmp_lt_u32 vcc, 1, v7
    s_nop 1
    v_cndmask_b32 v8, v8, v9, vcc
    v_and_b32 v9, 16, v2
    v_lshlrev_b32 v8, v9, v8
    v_and_b32 v8, 0xbfff0000, v8
    v_add_u32 v9, s35, v2
    v_cmp_eq_u32 vcc, 3, v7
    s_nop 1
    v_cndmask_b32 v3, 0, 16, vcc
    s_waitcnt vmcnt(13)
    v_alignbit_b32 v208, v209, v208, v3
    v_alignbit_b32 v209, v210, v209, v3
    v_alignbit_b32 v210, v211, v210, v3
    v_bfe_u32 v211, v211, v3, 16
    v_or_b32 v211, v211, v8
    buffer_store_dwordx4 v[208:211], v9, s[4:7], s44 offen sc1
    s_mul_i32 s36, s8, 12288
    s_add_u32 s36, s36, 2297856
    s_lshl_b32 s12, s9, 8
    s_lshr_b32 s13, s10, 1
    s_lshl_b32 s13, s13, 7
    s_add_u32 s12, s12, s13
    s_add_u32 s37, s12, s36
    s_and_b32 s12, s10, 1
    s_lshl_b32 s12, s12, 12
    s_add_u32 s37, s37, s12
    s_add_u32 s36, s36, s15
    s_bitcmp1_b32 s10, 0
    s_cselect_b32 s12, 2147418112, 0
    v_max_u32 v205, s12, v9
    v_max_u32 v12, s12, v2
    s_add_u32 s35, s44, 57344
    v_mov_b32 v200, 0
    v_mov_b32 v201, 0
    v_mov_b32 v202, 0
    v_mov_b32 v203, 0
    s_mov_b32 s47, s34
    s_mov_b32 s16, 0x3f803f80
    v_add_u32 v9, s15, v2
    v_lshlrev_b32 v224, 16, v208
    v_and_b32 v228, 0xffff0000, v208
    v_lshlrev_b32 v225, 16, v209
    v_and_b32 v229, 0xffff0000, v209
    v_lshlrev_b32 v226, 16, v210
    v_and_b32 v230, 0xffff0000, v210
    v_lshlrev_b32 v227, 16, v211
    v_and_b32 v231, 0xffff0000, v211
    v_permlane32_swap_b32 v224, v225
    v_permlane32_swap_b32 v226, v227
    v_permlane32_swap_b32 v228, v229
    v_permlane32_swap_b32 v230, v231
    s_add_u32 m0, s3, 12288
    s_nop 0
    buffer_load_dwordx4 v242, s[24:27], s56 offen offset:0 lds
    v_add_f32 v224, v224, v225
    v_add_f32 v226, v226, v227
    v_add_f32 v228, v228, v229
    v_add_f32 v230, v230, v231
    v_permlane16_swap_b32 v224, v226
    s_nop 0
    v_permlane16_swap_b32 v228, v230
    v_add_f32 v224, v224, v226
    v_add_f32 v228, v228, v230
    s_nop 0
    v_add_f32_dpp v224, v224, v224 row_ror:8 row_mask:0xf bank_mask:0xf
    v_add_f32_dpp v228, v228, v228 row_ror:8 row_mask:0xf bank_mask:0xf
    s_nop 0
    v_add_f32_dpp v224, v224, v224 row_ror:4 row_mask:0xf bank_mask:0xf
    v_add_f32_dpp v228, v228, v228 row_ror:4 row_mask:0xf bank_mask:0xf
    buffer_load_dwordx4 v243, s[24:27], s57 offen offset:1024 lds
    v_cvt_pk_bf16_f32 v225, v224, v228
    s_mov_b32 vcc_lo, 0xf0f0f0f0
    s_mov_b32 vcc_hi, 0xf0f0f0f0
    v_lshlrev_b32 v226, 16, v225
    v_and_b32 v227, 0xffff0000, v225
    v_sub_f32 v224, v224, v226
    v_sub_f32 v228, v228, v227
    v_cvt_pk_bf16_f32 v224, v224, v228
    v_cndmask_b32 v224, v225, v224, vcc
    s_mov_b32 s12, 0xffff
    v_mov_b32 v225, v224
    s_nop 1
    v_permlane32_swap_b32 v224, v225
    buffer_load_dwordx4 v242, s[24:27], s58 offen offset:2048 lds
    v_mov_b32 v226, v224
    v_mov_b32 v227, v225
    s_nop 0
    v_permlane16_swap_b32 v224, v226
    v_permlane16_swap_b32 v225, v227
    v_and_or_b32 v227, v227, s12, v8
    s_mov_b64 exec, 0xff
    buffer_store_dwordx4 v[224:227], v2, s[4:7], s37 offen sc1
    s_mov_b64 exec, -1
    s_waitcnt vmcnt(17)
    v_alignbit_b32 v212, v213, v212, v3
    v_alignbit_b32 v213, v214, v213, v3
    v_alignbit_b32 v214, v215, v214, v3
    v_bfe_u32 v215, v215, v3, 16
    buffer_load_dwordx4 v243, s[24:27], s59 offen offset:3072 lds
    v_or_b32 v215, v215, v8
    buffer_store_dwordx4 v[212:215], v205, s[4:7], s35 offen sc1
    s_add_u32 s37, s37, 8192
    v_lshlrev_b32 v232, 16, v212
    v_and_b32 v236, 0xffff0000, v212
    v_lshlrev_b32 v233, 16, v213
    v_and_b32 v237, 0xffff0000, v213
    v_lshlrev_b32 v234, 16, v214
    v_and_b32 v238, 0xffff0000, v214
    v_lshlrev_b32 v235, 16, v215
    v_and_b32 v239, 0xffff0000, v215
    v_permlane32_swap_b32 v232, v233
    s_add_u32 m0, s3, 40960
    s_nop 0
    buffer_load_dwordx4 v242, s[24:27], s56 offen offset:128 lds
    v_permlane32_swap_b32 v234, v235
    v_permlane32_swap_b32 v236, v237
    v_permlane32_swap_b32 v238, v239
    v_add_f32 v232, v232, v233
    v_add_f32 v234, v234, v235
    v_add_f32 v236, v236, v237
    v_add_f32 v238, v238, v239
    v_permlane16_swap_b32 v232, v234
    s_nop 0
    v_permlane16_swap_b32 v236, v238
    v_add_f32 v232, v232, v234
    v_add_f32 v236, v236, v238
    s_nop 0
    v_add_f32_dpp v232, v232, v232 row_ror:8 row_mask:0xf bank_mask:0xf
    buffer_load_dwordx4 v243, s[24:27], s57 offen offset:1152 lds
    v_add_f32_dpp v236, v236, v236 row_ror:8 row_mask:0xf bank_mask:0xf
    v_add_f32_dpp v232, v232, v232 row_ror:4 row_mask:0xf bank_mask:0xf
    s_nop 0
    v_add_f32_dpp v236, v236, v236 row_ror:4 row_mask:0xf bank_mask:0xf
    v_cvt_pk_bf16_f32 v233, v232, v236
    s_mov_b32 vcc_lo, 0xf0f0f0f0
    s_mov_b32 vcc_hi, 0xf0f0f0f0
    v_lshlrev_b32 v234, 16, v233
    v_and_b32 v235, 0xffff0000, v233
    v_sub_f32 v232, v232, v234
    v_sub_f32 v236, v236, v235
    v_cvt_pk_bf16_f32 v232, v232, v236
    v_cndmask_b32 v232, v233, v232, vcc
    s_mov_b32 s12, 0xffff
    v_mov_b32 v233, v232
    buffer_load_dwordx4 v242, s[24:27], s58 offen offset:2176 lds
    s_nop 0
    v_permlane32_swap_b32 v232, v233
    v_mov_b32 v234, v232
    v_mov_b32 v235, v233
    s_nop 0
    v_permlane16_swap_b32 v232, v234
    v_permlane16_swap_b32 v233, v235
    v_and_or_b32 v235, v235, s12, v8
    s_mov_b64 exec, 0xff
    buffer_store_dwordx4 v[232:235], v12, s[4:7], s37 offen sc1
    s_mov_b64 exec, -1
    s_waitcnt vmcnt(11)
    s_waitcnt lgkmcnt(0)
    s_barrier
    ds_read_b128 a[64:67], v160 offset:0
    buffer_load_dwordx4 v243, s[24:27], s59 offen offset:3200 lds
    ds_read_b128 a[0:3], v162 offset:0
    ds_read_b128 a[68:71], v161 offset:0
    ds_read_b128 a[4:7], v162 offset:2048
    ds_read_b128 a[72:75], v160 offset:4096
    ds_read_b128 a[8:11], v162 offset:4096
    ds_read_b128 a[76:79], v161 offset:4096
    ds_read_b128 a[12:15], v162 offset:6144
    ds_read_b128 a[80:83], v160 offset:8192
    ds_read_b128 a[16:19], v162 offset:8192
    ds_read_b128 a[84:87], v161 offset:8192
    ds_read_b128 a[20:23], v162 offset:10240
    ds_read_b128 a[88:91], v160 offset:12288
    s_add_u32 m0, s3, 143360
    s_nop 0
    buffer_load_dwordx4 v242, s[24:27], s56 offen offset:256 lds
    ds_read_b128 a[24:27], v162 offset:12288
    s_waitcnt lgkmcnt(12)
    v_mfma_f32_16x16x32_bf16 v[216:219], a[64:67], a[0:3], 0
    ds_read_b128 a[92:95], v161 offset:12288
    ds_read_b128 a[28:31], v162 offset:14336
    s_waitcnt lgkmcnt(12)
    v_mfma_f32_16x16x32_bf16 v[216:219], a[68:71], a[4:7], v[216:219]
    ds_read_b128 a[96:99], v160 offset:16384
    buffer_load_dwordx4 v243, s[24:27], s57 offen offset:1280 lds
    ds_read_b128 a[32:35], v162 offset:16384
    s_waitcnt lgkmcnt(12)
    v_mfma_f32_16x16x32_bf16 v[216:219], a[72:75], a[8:11], v[216:219]
    ds_read_b128 a[100:103], v161 offset:16384
    ds_read_b128 a[36:39], v162 offset:18432
    s_waitcnt lgkmcnt(12)
    v_mfma_f32_16x16x32_bf16 v[216:219], a[76:79], a[12:15], v[216:219]
    ds_read_b128 a[104:107], v160 offset:20480
    buffer_load_dwordx4 v242, s[24:27], s58 offen offset:2304 lds
    ds_read_b128 a[40:43], v162 offset:20480
    s_waitcnt lgkmcnt(12)
    v_mfma_f32_16x16x32_bf16 v[216:219], a[80:83], a[16:19], v[216:219]
    ds_read_b128 a[108:111], v161 offset:20480
    ds_read_b128 a[44:47], v162 offset:22528
    s_waitcnt lgkmcnt(12)
    v_mfma_f32_16x16x32_bf16 v[216:219], a[84:87], a[20:23], v[216:219]
    ds_read_b128 a[112:115], v160 offset:24576
    buffer_load_dwordx4 v243, s[24:27], s59 offen offset:3328 lds
    ds_read_b128 a[48:51], v162 offset:24576
    s_waitcnt lgkmcnt(12)
    v_mfma_f32_16x16x32_bf16 v[216:219], a[88:91], a[24:27], v[216:219]
    ds_read_b128 a[116:119], v161 offset:24576
    ds_read_b128 a[52:55], v162 offset:26624
    s_waitcnt lgkmcnt(12)
    v_mfma_f32_16x16x32_bf16 v[216:219], a[92:95], a[28:31], v[216:219]
    ds_read_u16 v206, v164 offset:0
    s_add_u32 m0, s15, 0
    s_add_u32 s44, s14, 0
    buffer_load_dwordx4 v2, s[4:7], s44 offen sc1 lds
    ds_read_u16 v207, v164 offset:128
    ds_read_u16 v208, v165 offset:256
    ds_read_u16 v209, v165 offset:384
    s_waitcnt lgkmcnt(14)
    v_mfma_f32_16x16x32_bf16 v[216:219], a[96:99], a[32:35], v[216:219]
    s_waitcnt lgkmcnt(12)
    v_mfma_f32_16x16x32_bf16 v[216:219], a[100:103], a[36:39], v[216:219]
    s_waitcnt lgkmcnt(10)
    v_mfma_f32_16x16x32_bf16 v[216:219], a[104:107], a[40:43], v[216:219]
    s_add_u32 m0, s15, 28736
    s_add_u32 s44, s14, 28672
    buffer_load_dwordx4 v2, s[4:7], s44 offen sc1 lds
    s_waitcnt lgkmcnt(8)
    v_mfma_f32_16x16x32_bf16 v[216:219], a[108:111], a[44:47], v[216:219]
    s_waitcnt lgkmcnt(6)
    v_mfma_f32_16x16x32_bf16 v[216:219], a[112:115], a[48:51], v[216:219]
    s_waitcnt lgkmcnt(4)
    v_mfma_f32_16x16x32_bf16 v[216:219], a[116:119], a[52:55], v[216:219]
    s_waitcnt vmcnt(12)
    ds_read_b128 v[16:19], v244 offset:12288
    ds_read_b128 v[20:23], v245 offset:12288
    ds_read_b128 v[24:27], v246 offset:12288
    ds_read_b128 v[28:31], v247 offset:12288
    ds_read_u16 v224, v166 offset:0
    ds_read_u16 v225, v166 offset:56
    ds_read_u16 v226, v166 offset:112
    ds_read_u16 v227, v166 offset:168
    ds_read_u16 v228, v166 offset:392
    ds_read_u16 v229, v166 offset:448
    ds_read_u16 v230, v166 offset:504
    ds_read_u16 v231, v166 offset:560
    ds_read_u16 v232, v166 offset:784
    ds_read_u16 v233, v166 offset:840
    ds_read_u16 v234, v166 offset:896
    ds_read_u16 v235, v166 offset:952
    s_add_u32 m0, s3, 57088
    s_nop 0
    buffer_load_dwordx4 v242, s[24:27], s56 offen offset:384 lds
    ds_read_u16 v236, v166 offset:1176
    ds_read_u16 v237, v166 offset:1232
    ds_read_u16 v238, v166 offset:1288
    ds_read_u16 v239, v166 offset:1344
    s_waitcnt lgkmcnt(15)
    v_lshl_or_b32 v222, v207, 16, v206
    v_lshl_or_b32 v223, v209, 16, v208
    v_cvt_pk_bf16_f32 v220, v216, v217
    v_cvt_pk_bf16_f32 v221, v218, v219
    s_nop 0
    v_permlane32_swap_b32 v220, v222
    v_permlane32_swap_b32 v221, v223
    buffer_store_dwordx4 v[220:223], v163, s[4:7], s47 offen sc1
    s_add_u32 s12, s15, 73856
    v_add_u32 v7, s12, v15
    buffer_load_dwordx4 v243, s[24:27], s57 offen offset:1408 lds
    v_add_u32 v6, s12, v2
    s_waitcnt lgkmcnt(14)
    v_lshl_or_b32 v224, v225, 16, v224
    v_and_b32 v224, v167, v224
    v_accvgpr_write_b32 a124, v224
    s_waitcnt lgkmcnt(12)
    v_lshl_or_b32 v226, v227, 16, v226
    v_and_b32 v226, v168, v226
    v_accvgpr_write_b32 a125, v226
    s_waitcnt lgkmcnt(10)
    v_lshl_or_b32 v228, v229, 16, v228
    v_and_b32 v228, v167, v228
    v_accvgpr_write_b32 a126, v228
    s_waitcnt lgkmcnt(8)
    v_lshl_or_b32 v230, v231, 16, v230
    v_and_b32 v230, v168, v230
    buffer_load_dwordx4 v242, s[24:27], s58 offen offset:2432 lds
    v_accvgpr_write_b32 a127, v230
    s_waitcnt lgkmcnt(6)
    v_lshl_or_b32 v232, v233, 16, v232
    v_and_b32 v232, v167, v232
    v_accvgpr_write_b32 a128, v232
    s_waitcnt lgkmcnt(4)
    v_lshl_or_b32 v234, v235, 16, v234
    v_and_b32 v234, v168, v234
    v_accvgpr_write_b32 a129, v234
    s_waitcnt lgkmcnt(2)
    v_lshl_or_b32 v236, v237, 16, v236
    v_and_b32 v236, v167, v236
    v_accvgpr_write_b32 a130, v236
    s_waitcnt lgkmcnt(0)
    v_lshl_or_b32 v238, v239, 16, v238
    v_and_b32 v238, v168, v238
    buffer_load_dwordx4 v243, s[24:27], s59 offen offset:3456 lds
    v_accvgpr_write_b32 a131, v238
    v_dot2c_f32_bf16 v200, s16, v192
    v_dot2c_f32_bf16 v202, v192, v192
    v_dot2c_f32_bf16 v201, s16, v196
    v_dot2c_f32_bf16 v203, v196, v196
    v_dot2c_f32_bf16 v200, s16, v193
    v_dot2c_f32_bf16 v202, v193, v193
    v_dot2c_f32_bf16 v201, s16, v197
    v_dot2c_f32_bf16 v203, v197, v197
    v_dot2c_f32_bf16 v200, s16, v194
    v_dot2c_f32_bf16 v202, v194, v194
    v_dot2c_f32_bf16 v201, s16, v198
    s_add_u32 m0, s15, 4096
    s_add_u32 s44, s14, 4096
    buffer_load_dwordx4 v2, s[4:7], s44 offen sc1 lds
    v_dot2c_f32_bf16 v203, v198, v198
    v_dot2c_f32_bf16 v200, s16, v195
    v_dot2c_f32_bf16 v202, v195, v195
    v_dot2c_f32_bf16 v201, s16, v199
    v_dot2c_f32_bf16 v203, v199, v199
    v_lshrrev_b32 v253, 1, v1
    v_mov_b32 v241, s42
    v_mov_b32 v204, s43
    v_permlane32_swap_b32 v200, v201
    v_permlane32_swap_b32 v202, v203
    v_add_f32 v200, v200, v201
    v_add_f32 v202, v202, v203
    s_mov_b32 vcc_lo, 0xffff0000
    s_mov_b32 vcc_hi, 0xffff0000
    v_permlane16_swap_b32 v200, v202
    s_add_u32 m0, s15, 32832
    s_add_u32 s44, s14, 32768
    buffer_load_dwordx4 v2, s[4:7], s44 offen sc1 lds
    v_add_f32 v240, v200, v202
    v_cndmask_b32 v241, v241, v204, vcc
    s_nop 0
    v_add_f32_dpp v240, v240, v240 row_ror:8 row_mask:0xf bank_mask:0xf
    s_nop 1
    v_add_f32_dpp v240, v240, v240 row_ror:4 row_mask:0xf bank_mask:0xf
    s_nop 1
    v_add_f32_dpp v240, v240, v240 row_ror:2 row_mask:0xf bank_mask:0xf
    s_nop 1
    v_add_f32_dpp v240, v240, v240 row_ror:1 row_mask:0xf bank_mask:0xf
    s_lshl_b32 s12, s8, 5
    s_add_u32 s12, s12, s55
    s_mov_b32 exec_lo, 0x10001
    s_mov_b32 exec_hi, 0x10001
    buffer_store_dwordx2 v[240:241], v253, s[4:7], s12 offen
    s_mov_b64 exec, -1
    s_lshl_b32 s12, s11, 15
    s_lshl_b32 s13, s8, 11
    s_add_u32 s12, s12, s13
    s_add_u32 s12, s12, 4460544
    v_mov_b32 v11, s12
    s_add_u32 s12, s53, 260096
    v_mov_b32 v3, s12
    s_add_u32 m0, s15, 8192
    s_add_u32 s44, s14, 8192
    buffer_load_dwordx4 v2, s[4:7], s44 offen sc1 lds
    v_cmp_lt_u32 vcc, 15, v1
    v_min_u32 v10, 17, v1
    v_mov_b32 v13, v8
    v_cndmask_b32 v11, v11, v3, vcc
    v_mov_b32 v14, 1024
    v_lshl_add_u32 v11, v10, 7, v11
    s_lshl_b32 s17, s19, 16
    s_and_b32 s12, s11, 7
    s_lshl_b32 s12, s12, 13
    s_add_u32 s17, s17, s12
    s_add_u32 s17, s17, 4096
    v_lshlrev_b32 v160, 7, v5
    s_add_u32 m0, s15, 36928
    s_add_u32 s44, s14, 36864
    buffer_load_dwordx4 v2, s[4:7], s44 offen sc1 lds
    v_accvgpr_write_b32 a180, v11
    v_mov_b32 v10, 0x3f803f80
    v_accvgpr_write_b32 a168, v10
    v_accvgpr_write_b32 a169, v10
    v_accvgpr_write_b32 a170, v10
    v_accvgpr_write_b32 a171, v10
    v_accvgpr_write_b32 a122, 0
    v_accvgpr_write_b32 a123, 0
    v_accvgpr_write_b32 a158, 0
    v_accvgpr_write_b32 a159, 0
    v_accvgpr_write_b32 a162, 0
    v_accvgpr_write_b32 a163, 0
    s_waitcnt vmcnt(16)
    ds_read_b128 v[32:35], v244 offset:41088
    ds_read_b128 v[36:39], v245 offset:41088
    ds_read_b128 v[40:43], v246 offset:41088
    ds_read_b128 v[44:47], v247 offset:41088
    v_accvgpr_write_b32 a166, 0
    v_accvgpr_write_b32 a167, 0
    v_add_u32 v162, 160000, v252
    v_lshl_add_u32 v163, s10, 2, v162
    v_min_u32 v161, 7, v1
    v_lshl_add_u32 v161, v161, 7, s41
    v_mov_b32 v10, s46
    v_cmp_lt_u32 vcc, 7, v1
    s_nop 1
    v_cndmask_b32 v161, v161, v10, vcc
    s_mov_b32 s47, s17
    s_waitcnt vmcnt(12)
    ds_read_b128 v[48:51], v248 offset:0
    ds_read_b128 v[52:55], v249 offset:0
    ds_read_b128 v[56:59], v250 offset:0
    ds_read_b128 v[60:63], v251 offset:0
    s_waitcnt lgkmcnt(0)
    s_add_u32 m0, s3, 143104
    s_nop 0
    buffer_load_dwordx4 v242, s[24:27], s56 offen offset:512 lds
    buffer_load_dwordx4 v243, s[24:27], s57 offen offset:1536 lds
    buffer_load_dwordx4 v242, s[24:27], s58 offen offset:2560 lds
    buffer_load_dwordx4 v243, s[24:27], s59 offen offset:3584 lds
    s_waitcnt vmcnt(14)
    ds_read_b32 v200, v9 offset:12
    ds_read_b32 v201, v9 offset:28748
    s_waitcnt lgkmcnt(0)
    v_xor_b32 v201, v8, v201
    v_bitop3_b32 v200, v8, v200, v201 bitop3:0xbe
    v_cmp_lt_u32 vcc, 0xffff, v200
    s_cbranch_vccnz L_m_rs_3
L_m_rb_4:
    s_barrier
    ds_read_b64_tr_b16 a[0:1], v15 offset:0
    ds_read_b64_tr_b16 a[2:3], v15 offset:256
    ds_read_b64_tr_b16 a[4:5], v15 offset:28736
    ds_read_b64_tr_b16 a[6:7], v15 offset:28992
    ds_read_b64_tr_b16 a[8:9], v15 offset:1024
    ds_read_b64_tr_b16 a[10:11], v15 offset:1280
    ds_read_b64_tr_b16 a[12:13], v15 offset:29760
    ds_read_b64_tr_b16 a[14:15], v15 offset:30016
    s_add_u32 m0, s15, 12288
    s_add_u32 s44, s14, 12288
    buffer_load_dwordx4 v2, s[4:7], s44 offen sc1 lds
    s_add_u32 m0, s15, 41024
    s_add_u32 s44, s14, 40960
    buffer_load_dwordx4 v2, s[4:7], s44 offen sc1 lds
    s_add_u32 m0, s15, 16384
    s_add_u32 s44, s14, 16384
    buffer_load_dwordx4 v2, s[4:7], s44 offen sc1 lds
    s_add_u32 m0, s15, 45120
    s_add_u32 s44, s14, 45056
    buffer_load_dwordx4 v2, s[4:7], s44 offen sc1 lds
    s_waitcnt lgkmcnt(6)
    v_mfma_f32_32x32x16_bf16 v[128:143], a[0:3], v[16:19], 0
    ds_read_b64_tr_b16 a[16:17], v15 offset:2048
    ds_read_b64_tr_b16 a[18:19], v15 offset:2304
    s_add_u32 m0, s15, 73856
    s_add_u32 s44, s36, 0
    buffer_load_dwordx4 v2, s[4:7], s44 offen sc1 lds
    s_waitcnt lgkmcnt(6)
    v_mfma_f32_32x32x16_bf16 v[144:159], a[4:7], v[16:19], 0
    ds_read_b64_tr_b16 a[20:21], v15 offset:30784
    ds_read_b64_tr_b16 a[22:23], v15 offset:31040
    s_waitcnt vmcnt(9)
    ds_read_b32 v200, v9 offset:4108
    ds_read_b32 v201, v9 offset:32844
    ds_read_b32 v202, v9 offset:8204
    ds_read_b32 v203, v9 offset:36940
    s_waitcnt lgkmcnt(10)
    v_mfma_f32_32x32x16_bf16 v[128:143], a[8:11], v[20:23], v[128:143]
    ds_read_b64_tr_b16 a[24:25], v15 offset:3072
    ds_read_b64_tr_b16 a[26:27], v15 offset:3328
    s_add_u32 m0, s15, 77952
    s_add_u32 s44, s36, 4096
    buffer_load_dwordx4 v2, s[4:7], s44 offen sc1 lds
    s_waitcnt lgkmcnt(10)
    v_mfma_f32_32x32x16_bf16 v[144:159], a[12:15], v[20:23], v[144:159]
    ds_read_b64_tr_b16 a[28:29], v15 offset:31808
    ds_read_b64_tr_b16 a[30:31], v15 offset:32064
    s_waitcnt vmcnt(15)
    ds_read_b128 v[64:67], v244 offset:57472
    ds_read_b128 v[68:71], v245 offset:57472
    ds_read_b128 v[72:75], v246 offset:57472
    ds_read_b128 v[76:79], v247 offset:57472
    s_waitcnt lgkmcnt(14)
    v_mfma_f32_32x32x16_bf16 v[128:143], a[16:19], v[24:27], v[128:143]
    s_waitcnt lgkmcnt(8)
    v_xor_b32 v203, v8, v203
    v_bitop3_b32 v202, v8, v202, v203 bitop3:0xbe
    v_bitop3_b32 v201, v8, v201, v202 bitop3:0xbe
    v_bitop3_b32 v200, v8, v200, v201 bitop3:0xbe
    v_cmp_lt_u32 vcc, 0xffff, v200
    s_cbranch_vccnz L_m_rs_5
L_m_rb_6:
    s_barrier
    ds_read_b64_tr_b16 a[0:1], v15 offset:4096
    ds_read_b64_tr_b16 a[2:3], v15 offset:4352
    v_mfma_f32_32x32x16_bf16 v[144:159], a[20:23], v[24:27], v[144:159]
    ds_read_b64_tr_b16 a[4:5], v15 offset:32832
    ds_read_b64_tr_b16 a[6:7], v15 offset:33088
    s_add_u32 m0, s15, 82048
    s_add_u32 s44, s36, 8192
    buffer_load_dwordx4 v2, s[4:7], s44 offen sc1 lds
    s_waitcnt lgkmcnt(10)
    v_mfma_f32_32x32x16_bf16 v[128:143], a[24:27], v[28:31], v[128:143]
    ds_read_b64_tr_b16 a[8:9], v15 offset:5120
    ds_read_b64_tr_b16 a[10:11], v15 offset:5376
    s_waitcnt lgkmcnt(10)
    v_mfma_f32_32x32x16_bf16 v[144:159], a[28:31], v[28:31], v[144:159]
    ds_read_b64_tr_b16 a[12:13], v15 offset:33856
    ds_read_b64_tr_b16 a[14:15], v15 offset:34112
    s_waitcnt lgkmcnt(6)
    v_mfma_f32_32x32x16_bf16 v[128:143], a[0:3], v[32:35], v[128:143]
    ds_read_b64_tr_b16 a[16:17], v15 offset:6144
    ds_read_b64_tr_b16 a[18:19], v15 offset:6400
    s_add_u32 m0, s3, 56832
    s_nop 0
    buffer_load_dwordx4 v242, s[24:27], s56 offen offset:640 lds
    s_waitcnt lgkmcnt(6)
    v_mfma_f32_32x32x16_bf16 v[144:159], a[4:7], v[32:35], v[144:159]
    ds_read_b64_tr_b16 a[20:21], v15 offset:34880
    ds_read_b64_tr_b16 a[22:23], v15 offset:35136
    buffer_load_dwordx4 v243, s[24:27], s57 offen offset:1664 lds
    s_waitcnt lgkmcnt(6)
    v_mfma_f32_32x32x16_bf16 v[128:143], a[8:11], v[36:39], v[128:143]
    ds_read_b64_tr_b16 a[24:25], v15 offset:7168
    ds_read_b64_tr_b16 a[26:27], v15 offset:7424
    buffer_load_dwordx4 v242, s[24:27], s58 offen offset:2688 lds
    s_waitcnt lgkmcnt(6)
    v_mfma_f32_32x32x16_bf16 v[144:159], a[12:15], v[36:39], v[144:159]
    ds_read_b64_tr_b16 a[28:29], v15 offset:35904
    ds_read_b64_tr_b16 a[30:31], v15 offset:36160
    s_waitcnt vmcnt(10)
    ds_read_b128 v[80:83], v248 offset:0
    ds_read_b128 v[84:87], v249 offset:0
    ds_read_b128 v[88:91], v250 offset:0
    ds_read_b128 v[92:95], v251 offset:0
    s_waitcnt lgkmcnt(10)
    v_mfma_f32_32x32x16_bf16 v[128:143], a[16:19], v[40:43], v[128:143]
    ds_read_b64_tr_b16 a[0:1], v15 offset:8192
    ds_read_b64_tr_b16 a[2:3], v15 offset:8448
    buffer_load_dwordx4 v243, s[24:27], s59 offen offset:3712 lds
    s_waitcnt lgkmcnt(10)
    v_mfma_f32_32x32x16_bf16 v[144:159], a[20:23], v[40:43], v[144:159]
    ds_read_b64_tr_b16 a[4:5], v15 offset:36928
    ds_read_b64_tr_b16 a[6:7], v15 offset:37184
    s_add_u32 m0, s15, 20480
    s_add_u32 s44, s14, 20480
    buffer_load_dwordx4 v2, s[4:7], s44 offen sc1 lds
    s_waitcnt lgkmcnt(10)
    v_mfma_f32_32x32x16_bf16 v[128:143], a[24:27], v[44:47], v[128:143]
    ds_read_b64_tr_b16 a[8:9], v15 offset:9216
    ds_read_b64_tr_b16 a[10:11], v15 offset:9472
    s_add_u32 m0, s15, 49216
    s_add_u32 s44, s14, 49152
    buffer_load_dwordx4 v2, s[4:7], s44 offen sc1 lds
    s_waitcnt lgkmcnt(10)
    v_mfma_f32_32x32x16_bf16 v[144:159], a[28:31], v[44:47], v[144:159]
    ds_read_b64_tr_b16 a[12:13], v15 offset:37952
    ds_read_b64_tr_b16 a[14:15], v15 offset:38208
    s_add_u32 m0, s15, 24576
    s_add_u32 s44, s14, 24576
    buffer_load_dwordx4 v2, s[4:7], s44 offen sc1 lds
    s_waitcnt lgkmcnt(6)
    v_mfma_f32_32x32x16_bf16 v[128:143], a[0:3], v[48:51], v[128:143]
    ds_read_b64_tr_b16 a[16:17], v15 offset:10240
    ds_read_b64_tr_b16 a[18:19], v15 offset:10496
    s_add_u32 m0, s15, 53312
    s_add_u32 s44, s14, 53248
    buffer_load_dwordx4 v2, s[4:7], s44 offen sc1 lds
    s_waitcnt lgkmcnt(6)
    v_mfma_f32_32x32x16_bf16 v[144:159], a[4:7], v[48:51], v[144:159]
    ds_read_b64_tr_b16 a[20:21], v15 offset:38976
    ds_read_b64_tr_b16 a[22:23], v15 offset:39232
    s_waitcnt vmcnt(8)
    ds_read_b32 v200, v9 offset:12300
    ds_read_b32 v201, v9 offset:41036
    ds_read_b32 v202, v9 offset:16396
    ds_read_b32 v203, v9 offset:45132
    ds_read_b32 v204, v6 offset:12
    ds_read_b32 v205, v6 offset:4108
    ds_read_b32 v206, v6 offset:8204
    s_waitcnt lgkmcnt(13)
    v_mfma_f32_32x32x16_bf16 v[128:143], a[8:11], v[52:55], v[128:143]
    ds_read_b64_tr_b16 a[24:25], v15 offset:11264
    ds_read_b64_tr_b16 a[26:27], v15 offset:11520
    s_add_u32 m0, s3, 142848
    s_nop 0
    buffer_load_dwordx4 v242, s[24:27], s56 offen offset:768 lds
    s_waitcnt lgkmcnt(13)
    v_mfma_f32_32x32x16_bf16 v[144:159], a[12:15], v[52:55], v[144:159]
    ds_read_b64_tr_b16 a[28:29], v15 offset:40000
    ds_read_b64_tr_b16 a[30:31], v15 offset:40256
    buffer_load_dwordx4 v243, s[24:27], s57 offen offset:1792 lds
    s_waitcnt lgkmcnt(13)
    v_mfma_f32_32x32x16_bf16 v[128:143], a[16:19], v[56:59], v[128:143]
    s_waitcnt lgkmcnt(4)
    v_xor_b32 v206, v8, v206
    v_bitop3_b32 v205, v8, v205, v206 bitop3:0xbe
    v_bitop3_b32 v204, v8, v204, v205 bitop3:0xbe
    v_bitop3_b32 v203, v8, v203, v204 bitop3:0xbe
    v_bitop3_b32 v202, v8, v202, v203 bitop3:0xbe
    v_bitop3_b32 v201, v8, v201, v202 bitop3:0xbe
    v_bitop3_b32 v200, v8, v200, v201 bitop3:0xbe
    v_cmp_lt_u32 vcc, 0xffff, v200
    s_cbranch_vccnz L_m_rs_7
L_m_rb_8:
    s_barrier
    ds_read_b64_tr_b16 a[0:1], v15 offset:12288
    ds_read_b64_tr_b16 a[2:3], v15 offset:12544
    v_mfma_f32_32x32x16_bf16 v[144:159], a[20:23], v[56:59], v[144:159]
    ds_read_b64_tr_b16 a[4:5], v15 offset:41024
    ds_read_b64_tr_b16 a[6:7], v15 offset:41280
    ds_read_b64_tr_b16 a[64:65], v7 offset:0
    ds_read_b64_tr_b16 a[66:67], v7 offset:256
    ds_read_b64_tr_b16 a[68:69], v7 offset:4096
    s_waitcnt lgkmcnt(9)
    v_mfma_f32_32x32x16_bf16 v[128:143], a[24:27], v[60:63], v[128:143]
    ds_read_b64_tr_b16 a[8:9], v15 offset:13312
    ds_read_b64_tr_b16 a[10:11], v15 offset:13568
    buffer_load_dwordx4 v242, s[24:27], s58 offen offset:2816 lds
    s_waitcnt lgkmcnt(9)
    v_mfma_f32_32x32x16_bf16 v[144:159], a[28:31], v[60:63], v[144:159]
    ds_read_b64_tr_b16 a[12:13], v15 offset:42048
    ds_read_b64_tr_b16 a[14:15], v15 offset:42304
    ds_read_b64_tr_b16 a[70:71], v7 offset:4352
    ds_read_b64_tr_b16 a[72:73], v7 offset:8192
    ds_read_b64_tr_b16 a[74:75], v7 offset:8448
    s_waitcnt lgkmcnt(12)
    v_mfma_f32_32x32x16_bf16 v[128:143], a[0:3], v[64:67], v[128:143]
    ds_read_b64_tr_b16 a[16:17], v15 offset:14336
    ds_read_b64_tr_b16 a[18:19], v15 offset:14592
    buffer_load_dwordx4 v243, s[24:27], s59 offen offset:3840 lds
    s_waitcnt lgkmcnt(12)
    v_mfma_f32_32x32x16_bf16 v[144:159], a[4:7], v[64:67], v[144:159]
    ds_read_b64_tr_b16 a[20:21], v15 offset:43072
    ds_read_b64_tr_b16 a[22:23], v15 offset:43328
    buffer_load_dwordx4 v[192:195], v252, s[4:7], s55 offen sc1
    s_waitcnt lgkmcnt(12)
    v_mfma_f32_32x32x16_bf16 v[208:223], a[168:171], a[64:67], 0
    s_waitcnt lgkmcnt(9)
    v_mfma_f32_32x32x16_bf16 v[128:143], a[8:11], v[68:71], v[128:143]
    ds_read_b64_tr_b16 a[24:25], v15 offset:15360
    ds_read_b64_tr_b16 a[26:27], v15 offset:15616
    buffer_load_dword v0, v161, s[20:23], 0 offen sc1
    s_waitcnt lgkmcnt(9)
    v_mfma_f32_32x32x16_bf16 v[144:159], a[12:15], v[68:71], v[144:159]
    ds_read_b64_tr_b16 a[28:29], v15 offset:44096
    ds_read_b64_tr_b16 a[30:31], v15 offset:44352
    s_waitcnt lgkmcnt(10)
    v_mfma_f32_32x32x16_bf16 v[224:239], a[168:171], a[68:71], 0
    s_waitcnt lgkmcnt(6)
    v_mfma_f32_32x32x16_bf16 v[128:143], a[16:19], v[72:75], v[128:143]
    ds_read_b64_tr_b16 a[0:1], v15 offset:16384
    ds_read_b64_tr_b16 a[2:3], v15 offset:16640
    s_waitcnt lgkmcnt(6)
    v_mfma_f32_32x32x16_bf16 v[144:159], a[20:23], v[72:75], v[144:159]
    ds_read_b64_tr_b16 a[4:5], v15 offset:45120
    ds_read_b64_tr_b16 a[6:7], v15 offset:45376
    v_mfma_f32_32x32x16_bf16 v[176:191], a[168:171], a[72:75], 0
    s_waitcnt lgkmcnt(6)
    v_mfma_f32_32x32x16_bf16 v[128:143], a[24:27], v[76:79], v[128:143]
    ds_read_b64_tr_b16 a[8:9], v15 offset:17408
    ds_read_b64_tr_b16 a[10:11], v15 offset:17664
    s_waitcnt lgkmcnt(6)
    v_mfma_f32_32x32x16_bf16 v[144:159], a[28:31], v[76:79], v[144:159]
    ds_read_b64_tr_b16 a[12:13], v15 offset:46144
    ds_read_b64_tr_b16 a[14:15], v15 offset:46400
    s_waitcnt vmcnt(10)
    ds_read_b128 v[96:99], v244 offset:57472
    ds_read_b128 v[100:103], v245 offset:57472
    ds_read_b128 v[104:107], v246 offset:57472
    ds_read_b128 v[108:111], v247 offset:57472
    s_waitcnt lgkmcnt(10)
    v_mfma_f32_32x32x16_bf16 v[128:143], a[0:3], v[80:83], v[128:143]
    ds_read_b64_tr_b16 a[16:17], v15 offset:18432
    ds_read_b64_tr_b16 a[18:19], v15 offset:18688
    ds_write_b32 v163, v208 offset:0
    ds_write_b32 v163, v224 offset:512
    ds_write_b32 v163, v176 offset:1024
    s_waitcnt lgkmcnt(13)
    v_mfma_f32_32x32x16_bf16 v[144:159], a[4:7], v[80:83], v[144:159]
    ds_read_b64_tr_b16 a[20:21], v15 offset:47168
    ds_read_b64_tr_b16 a[22:23], v15 offset:47424
    s_waitcnt vmcnt(6)
    ds_read_b32 v200, v9 offset:20492
    ds_read_b32 v201, v9 offset:49228
    ds_read_b32 v202, v9 offset:24588
    ds_read_b32 v203, v9 offset:53324
    s_waitcnt lgkmcnt(15)
    v_mfma_f32_32x32x16_bf16 v[128:143], a[8:11], v[84:87], v[128:143]
    ds_read_b64_tr_b16 a[24:25], v15 offset:19456
    ds_read_b64_tr_b16 a[26:27], v15 offset:19712
    v_mfma_f32_32x32x16_bf16 v[144:159], a[12:15], v[84:87], v[144:159]
    ds_read_b64_tr_b16 a[28:29], v15 offset:48192
    ds_read_b64_tr_b16 a[30:31], v15 offset:48448
    s_waitcnt lgkmcnt(13)
    v_mfma_f32_32x32x16_bf16 v[128:143], a[16:19], v[88:91], v[128:143]
    s_waitcnt lgkmcnt(4)
    v_xor_b32 v203, v8, v203
    v_bitop3_b32 v202, v8, v202, v203 bitop3:0xbe
    v_bitop3_b32 v201, v8, v201, v202 bitop3:0xbe
    v_bitop3_b32 v200, v8, v200, v201 bitop3:0xbe
    v_cmp_lt_u32 vcc, 0xffff, v200
    s_cbranch_vccnz L_m_rs_9
L_m_rb_10:
    s_barrier
    ds_read_b64_tr_b16 a[0:1], v15 offset:20480
    ds_read_b64_tr_b16 a[2:3], v15 offset:20736
    v_mfma_f32_32x32x16_bf16 v[144:159], a[20:23], v[88:91], v[144:159]
    ds_read_b64_tr_b16 a[4:5], v15 offset:49216
    ds_read_b64_tr_b16 a[6:7], v15 offset:49472
    ds_read_b128 v[208:211], v162 offset:0
    ds_read_b128 v[212:215], v162 offset:512
    ds_read_b128 v[216:219], v162 offset:1024
    s_waitcnt lgkmcnt(9)
    v_mfma_f32_32x32x16_bf16 v[128:143], a[24:27], v[92:95], v[128:143]
    ds_read_b64_tr_b16 a[8:9], v15 offset:21504
    ds_read_b64_tr_b16 a[10:11], v15 offset:21760
    s_waitcnt vmcnt(1)
    v_cmp_ne_u32 vcc, s42, v193
    v_cmp_ne_u32 s[32:33], s43, v195
    s_nop 0
    s_or_b64 vcc, vcc, s[32:33]
    s_cbranch_scc1 L_m_s0_11
L_m_s0r_12:
    s_waitcnt lgkmcnt(9)
    v_mfma_f32_32x32x16_bf16 v[144:159], a[28:31], v[92:95], v[144:159]
    ds_read_b64_tr_b16 a[12:13], v15 offset:50240
    ds_read_b64_tr_b16 a[14:15], v15 offset:50496
    v_mov_b32 v196, 0x3727c5ac
    v_mul_f32 v192, 0xbb124925, v192
    s_add_u32 m0, s15, 57472
    s_add_u32 s44, s14, 57344
    buffer_load_dwordx4 v2, s[4:7], s44 offen sc1 lds
    s_waitcnt lgkmcnt(9)
    v_mfma_f32_32x32x16_bf16 v[128:143], a[0:3], v[96:99], v[128:143]
    ds_read_b64_tr_b16 a[16:17], v15 offset:22528
    ds_read_b64_tr_b16 a[18:19], v15 offset:22784
    v_mul_f32 v198, 0.5, v192
    v_cvt_pk_bf16_f32 v197, v198, v198
    v_accvgpr_write_b32 a120, v197
    v_lshlrev_b32 v197, 16, v197
    s_waitcnt lgkmcnt(9)
    v_mfma_f32_32x32x16_bf16 v[144:159], a[4:7], v[96:99], v[144:159]
    ds_read_b64_tr_b16 a[20:21], v15 offset:51264
    ds_read_b64_tr_b16 a[22:23], v15 offset:51520
    v_sub_f32 v198, v198, v197
    v_cvt_pk_bf16_f32 v198, v198, 0
    s_add_u32 m0, s15, 61568
    s_add_u32 s44, s14, 61440
    buffer_load_dwordx4 v2, s[4:7], s44 offen sc1 lds
    s_waitcnt lgkmcnt(6)
    v_mfma_f32_32x32x16_bf16 v[128:143], a[8:11], v[100:103], v[128:143]
    ds_read_b64_tr_b16 a[24:25], v15 offset:23552
    ds_read_b64_tr_b16 a[26:27], v15 offset:23808
    v_accvgpr_write_b32 a121, v198
    v_add_f32 v208, v208, v209
    v_add_f32 v210, v210, v211
    v_add_f32 v208, v208, v210
    s_waitcnt lgkmcnt(6)
    v_mfma_f32_32x32x16_bf16 v[144:159], a[12:15], v[100:103], v[144:159]
    ds_read_b64_tr_b16 a[28:29], v15 offset:52288
    ds_read_b64_tr_b16 a[30:31], v15 offset:52544
    s_waitcnt vmcnt(4)
    ds_read_b128 v[112:115], v248 offset:0
    ds_read_b128 v[116:119], v249 offset:0
    ds_read_b128 v[120:123], v250 offset:0
    ds_read_b128 v[124:127], v251 offset:0
    s_add_u32 m0, s15, 65664
    s_add_u32 s44, s14, 65536
    buffer_load_dwordx4 v2, s[4:7], s44 offen sc1 lds
    s_waitcnt lgkmcnt(10)
    v_mfma_f32_32x32x16_bf16 v[128:143], a[16:19], v[104:107], v[128:143]
    ds_read_b64_tr_b16 a[0:1], v15 offset:24576
    ds_read_b64_tr_b16 a[2:3], v15 offset:24832
    v_cvt_pk_bf16_f32 v209, v208, v208
    v_accvgpr_write_b32 a157, v209
    v_lshlrev_b32 v209, 16, v209
    v_sub_f32 v209, v208, v209
    s_waitcnt lgkmcnt(10)
    v_mfma_f32_32x32x16_bf16 v[144:159], a[20:23], v[104:107], v[144:159]
    ds_read_b64_tr_b16 a[4:5], v15 offset:53312
    ds_read_b64_tr_b16 a[6:7], v15 offset:53568
    v_cvt_pk_bf16_f32 v208, v208, v209
    v_accvgpr_write_b32 a156, v208
    s_add_u32 m0, s15, 69760
    s_add_u32 s44, s14, 69632
    buffer_load_dwordx4 v2, s[4:7], s44 offen sc1 lds
    s_waitcnt lgkmcnt(10)
    v_mfma_f32_32x32x16_bf16 v[128:143], a[24:27], v[108:111], v[128:143]
    ds_read_b64_tr_b16 a[8:9], v15 offset:25600
    ds_read_b64_tr_b16 a[10:11], v15 offset:25856
    v_add_f32 v212, v212, v213
    v_add_f32 v214, v214, v215
    v_add_f32 v212, v212, v214
    v_cvt_pk_bf16_f32 v213, v212, v212
    s_waitcnt lgkmcnt(10)
    v_mfma_f32_32x32x16_bf16 v[144:159], a[28:31], v[108:111], v[144:159]
    ds_read_b64_tr_b16 a[12:13], v15 offset:54336
    ds_read_b64_tr_b16 a[14:15], v15 offset:54592
    v_accvgpr_write_b32 a161, v213
    v_lshlrev_b32 v213, 16, v213
    s_add_u32 m0, s15, 73856
    s_add_u32 s44, s14, 73728
    buffer_load_dwordx4 v2, s[4:7], s44 offen sc1 lds
    s_waitcnt lgkmcnt(6)
    v_mfma_f32_32x32x16_bf16 v[128:143], a[0:3], v[112:115], v[128:143]
    ds_read_b64_tr_b16 a[16:17], v15 offset:26624
    ds_read_b64_tr_b16 a[18:19], v15 offset:26880
    v_sub_f32 v213, v212, v213
    v_cvt_pk_bf16_f32 v212, v212, v213
    v_accvgpr_write_b32 a160, v212
    v_fmac_f32 v196, 0x3b124925, v194
    s_waitcnt lgkmcnt(6)
    v_mfma_f32_32x32x16_bf16 v[144:159], a[4:7], v[112:115], v[144:159]
    ds_read_b64_tr_b16 a[20:21], v15 offset:55360
    ds_read_b64_tr_b16 a[22:23], v15 offset:55616
    v_fma_f32 v196, -v192, v192, v196
    v_rsq_f32 v12, v196
    s_add_u32 m0, s15, 77952
    s_add_u32 s44, s14, 77824
    buffer_load_dwordx4 v2, s[4:7], s44 offen sc1 lds
    s_waitcnt lgkmcnt(6)
    v_mfma_f32_32x32x16_bf16 v[128:143], a[8:11], v[116:119], v[128:143]
    ds_read_b64_tr_b16 a[24:25], v15 offset:27648
    ds_read_b64_tr_b16 a[26:27], v15 offset:27904
    v_mul_f32 v10, 0x3fb8aa3b, v12
    v_mul_f32 v12, v196, v12
    v_mul_u32_u24 v7, 224, v5
    v_lshl_add_u32 v7, v4, 5, v7
    s_waitcnt lgkmcnt(6)
    v_mfma_f32_32x32x16_bf16 v[144:159], a[12:15], v[116:119], v[144:159]
    ds_read_b64_tr_b16 a[28:29], v15 offset:56384
    ds_read_b64_tr_b16 a[30:31], v15 offset:56640
    s_mul_i32 s12, s10, 7168
    v_add_u32 v7, s12, v7
    v_add_u32 v7, 114880, v7
    s_add_u32 m0, s15, 82048
    s_add_u32 s44, s14, 81920
    buffer_load_dwordx4 v2, s[4:7], s44 offen sc1 lds
    s_waitcnt lgkmcnt(6)
    v_mfma_f32_32x32x16_bf16 v[128:143], a[16:19], v[120:123], v[128:143]
    v_lshrrev_b32 v6, 2, v1
    v_mul_u32_u24 v6, 224, v6
    v_and_b32 v9, 3, v1
    v_lshl_add_u32 v6, v9, 3, v6
    v_mov_b32 v9, v6
    s_waitcnt lgkmcnt(4)
    v_mfma_f32_32x32x16_bf16 v[144:159], a[20:23], v[120:123], v[144:159]
    s_and_b32 s12, s10, 1
    s_lshl_b32 s12, s12, 5
    s_add_u32 s12, s12, 115008
    v_add_u32 v6, s12, v6
    s_and_b32 s12, s10, 2
    s_lshl_b32 s12, s12, 5
    s_add_u32 s12, s12, 114880
    v_add_u32 v9, s12, v9
    v_add_u32 v11, 86208, v2
    v_add_f32 v216, v216, v217
    s_waitcnt lgkmcnt(2)
    v_mfma_f32_32x32x16_bf16 v[128:143], a[24:27], v[124:127], v[128:143]
    v_add_f32 v218, v218, v219
    v_add_f32 v216, v216, v218
    v_cvt_pk_bf16_f32 v217, v216, v216
    v_accvgpr_write_b32 a165, v217
    v_lshlrev_b32 v217, 16, v217
    v_mfma_f32_32x32x16_bf16 v[128:143], a[156:159], a[120:123], v[128:143]
    v_sub_f32 v217, v216, v217
    v_cvt_pk_bf16_f32 v216, v216, v217
    v_accvgpr_write_b32 a164, v216
    v_mov_b32 v176, -1
    v_mov_b32 v177, -1
    s_waitcnt lgkmcnt(0)
    v_mfma_f32_32x32x16_bf16 v[144:159], a[28:31], v[124:127], v[144:159]
    v_mov_b32 v178, -1
    v_mov_b32 v179, -1
    v_mfma_f32_32x32x16_bf16 v[144:159], a[160:163], a[120:123], v[144:159]
    s_nop 1
    v_cvt_pk_bf16_f32 v192, v128, v129
    v_cvt_pk_bf16_f32 v193, v130, v131
    v_cvt_pk_bf16_f32 v194, v132, v133
    v_cvt_pk_bf16_f32 v195, v134, v135
    v_cvt_pk_bf16_f32 v196, v136, v137
    v_cvt_pk_bf16_f32 v197, v138, v139
    v_cvt_pk_bf16_f32 v198, v140, v141
    v_cvt_pk_bf16_f32 v199, v142, v143
    v_mfma_f32_32x32x16_bf16 v[128:143], a[124:127], v[192:195], 0
    s_nop 0
    v_mfma_f32_32x32x16_bf16 v[128:143], a[128:131], v[196:199], v[128:143]
    s_mov_b32 exec_lo, 0
    v_mov_b32 v147, v12
    v_mov_b32 v155, v12
    s_mov_b32 exec_lo, -1
    v_cvt_pk_bf16_f32 v232, v144, v145
    v_cvt_pk_bf16_f32 v233, v146, v147
    v_cvt_pk_bf16_f32 v234, v148, v149
    v_cvt_pk_bf16_f32 v235, v150, v151
    v_cvt_pk_bf16_f32 v236, v152, v153
    v_cvt_pk_bf16_f32 v237, v154, v155
    v_cvt_pk_bf16_f32 v238, v156, v157
    v_cvt_pk_bf16_f32 v239, v158, v159
    ds_write_b128 v7, v[232:235] offset:128
    ds_write_b128 v7, v[236:239] offset:144
    v_max3_f32 v192, v128, v129, v130
    v_min3_f32 v194, v128, v129, v130
    v_lshrrev_b32 v168, 3, v1
    v_mul_u32_u24 v168, 115072, v168
    v_and_b32 v169, 0x70, v2
    v_add3_u32 v168, v168, v169, s18
    s_lshl_b32 s12, s8, 13
    s_lshl_b32 s13, s45, 7
    s_add_u32 s12, s12, s13
    buffer_store_dwordx4 v[176:179], v168, s[20:23], s12 offen sc1
    s_add_u32 s12, s12, 920576
    buffer_store_dwordx4 v[176:179], v168, s[20:23], s12 offen sc1
    v_max3_f32 v192, v192, v131, v132
    v_min3_f32 v194, v194, v131, v132
    v_max3_f32 v192, v192, v133, v134
    v_min3_f32 v194, v194, v133, v134
    v_max3_f32 v192, v192, v135, v136
    v_min3_f32 v194, v194, v135, v136
    v_max3_f32 v192, v192, v137, v138
    v_min3_f32 v194, v194, v137, v138
    v_max3_f32 v192, v192, v139, v140
    v_min3_f32 v194, v194, v139, v140
    v_max_f32 v192, v192, v141
    buffer_load_dword v0, v160, s[4:7], s47 offen sc1
    s_add_u32 s47, s47, 4096
    buffer_load_dword v0, v160, s[4:7], s47 offen sc1
    v_min_f32 v194, v194, v141
    v_mov_b32 v196, v192
    v_mov_b32 v197, v194
    s_nop 0
    v_permlane32_swap_b32 v196, v192
    v_permlane32_swap_b32 v197, v194
    v_max_f32 v192, v192, v196
    v_min_f32 v194, v194, v197
    v_mul_f32 v192, v192, v10
    v_mul_f32 v194, v194, v10
    v_pk_fma_f32 v[198:199], v[128:129], v[10:11], v[192:193] op_sel_hi:[1,0,0] neg_lo:[0,0,1] neg_hi:[0,0,1]
    v_pk_fma_f32 v[200:201], v[130:131], v[10:11], v[192:193] op_sel_hi:[1,0,0] neg_lo:[0,0,1] neg_hi:[0,0,1]
    v_pk_fma_f32 v[202:203], v[132:133], v[10:11], v[192:193] op_sel_hi:[1,0,0] neg_lo:[0,0,1] neg_hi:[0,0,1]
    v_pk_fma_f32 v[204:205], v[134:135], v[10:11], v[192:193] op_sel_hi:[1,0,0] neg_lo:[0,0,1] neg_hi:[0,0,1]
    v_pk_fma_f32 v[206:207], v[136:137], v[10:11], v[192:193] op_sel_hi:[1,0,0] neg_lo:[0,0,1] neg_hi:[0,0,1]
    v_pk_fma_f32 v[208:209], v[138:139], v[10:11], v[192:193] op_sel_hi:[1,0,0] neg_lo:[0,0,1] neg_hi:[0,0,1]
    v_pk_fma_f32 v[210:211], v[140:141], v[10:11], v[192:193] op_sel_hi:[1,0,0] neg_lo:[0,0,1] neg_hi:[0,0,1]
    v_pk_fma_f32 v[212:213], v[128:129], v[10:11], v[194:195] op_sel_hi:[1,0,0] neg_lo:[1,0,0] neg_hi:[1,0,0]
    v_pk_fma_f32 v[214:215], v[130:131], v[10:11], v[194:195] op_sel_hi:[1,0,0] neg_lo:[1,0,0] neg_hi:[1,0,0]
    v_pk_fma_f32 v[216:217], v[132:133], v[10:11], v[194:195] op_sel_hi:[1,0,0] neg_lo:[1,0,0] neg_hi:[1,0,0]
    v_pk_fma_f32 v[218:219], v[134:135], v[10:11], v[194:195] op_sel_hi:[1,0,0] neg_lo:[1,0,0] neg_hi:[1,0,0]
    v_pk_fma_f32 v[220:221], v[136:137], v[10:11], v[194:195] op_sel_hi:[1,0,0] neg_lo:[1,0,0] neg_hi:[1,0,0]
    v_pk_fma_f32 v[222:223], v[138:139], v[10:11], v[194:195] op_sel_hi:[1,0,0] neg_lo:[1,0,0] neg_hi:[1,0,0]
    v_pk_fma_f32 v[224:225], v[140:141], v[10:11], v[194:195] op_sel_hi:[1,0,0] neg_lo:[1,0,0] neg_hi:[1,0,0]
    v_exp_f32 v198, v198
    v_exp_f32 v199, v199
    v_exp_f32 v200, v200
    v_exp_f32 v201, v201
    v_exp_f32 v202, v202
    v_exp_f32 v203, v203
    v_exp_f32 v204, v204
    v_exp_f32 v205, v205
    v_exp_f32 v206, v206
    v_exp_f32 v207, v207
    v_exp_f32 v208, v208
    v_exp_f32 v209, v209
    v_exp_f32 v210, v210
    v_exp_f32 v211, v211
    v_exp_f32 v212, v212
    v_exp_f32 v213, v213
    v_exp_f32 v214, v214
    v_exp_f32 v215, v215
    v_exp_f32 v216, v216
    v_exp_f32 v217, v217
    v_exp_f32 v218, v218
    v_exp_f32 v219, v219
    v_exp_f32 v220, v220
    v_exp_f32 v221, v221
    v_exp_f32 v222, v222
    v_exp_f32 v223, v223
    v_exp_f32 v224, v224
    v_exp_f32 v225, v225
    v_pk_add_f32 v[192:193], v[198:199], v[200:201]
    v_pk_add_f32 v[194:195], v[212:213], v[214:215]
    v_pk_add_f32 v[192:193], v[192:193], v[202:203]
    v_pk_add_f32 v[194:195], v[194:195], v[216:217]
    v_pk_add_f32 v[192:193], v[192:193], v[204:205]
    v_pk_add_f32 v[194:195], v[194:195], v[218:219]
    v_pk_add_f32 v[192:193], v[192:193], v[206:207]
    v_pk_add_f32 v[194:195], v[194:195], v[220:221]
    v_pk_add_f32 v[192:193], v[192:193], v[208:209]
    v_pk_add_f32 v[194:195], v[194:195], v[222:223]
    v_pk_add_f32 v[192:193], v[192:193], v[210:211]
    v_pk_add_f32 v[194:195], v[194:195], v[224:225]
    v_add_f32 v192, v192, v193
    v_add_f32 v194, v194, v195
    v_mov_b32 v196, v192
    v_mov_b32 v197, v194
    s_nop 0
    v_permlane32_swap_b32 v196, v192
    v_permlane32_swap_b32 v197, v194
    v_add_f32 v192, v192, v196
    v_add_f32 v194, v194, v197
    v_mul_f32 v192, v192, v12
    v_mul_f32 v194, v194, v12
    v_rcp_f32 v192, v192
    v_rcp_f32 v194, v194
    v_pk_mul_f32 v[198:199], v[198:199], v[192:193] op_sel_hi:[1,0]
    v_pk_mul_f32 v[200:201], v[200:201], v[192:193] op_sel_hi:[1,0]
    v_pk_mul_f32 v[202:203], v[202:203], v[192:193] op_sel_hi:[1,0]
    v_pk_mul_f32 v[204:205], v[204:205], v[192:193] op_sel_hi:[1,0]
    v_pk_mul_f32 v[206:207], v[206:207], v[192:193] op_sel_hi:[1,0]
    v_pk_mul_f32 v[208:209], v[208:209], v[192:193] op_sel_hi:[1,0]
    v_pk_mul_f32 v[210:211], v[210:211], v[192:193] op_sel_hi:[1,0]
    v_cvt_pk_bf16_f32 v240, v198, v199
    v_cvt_pk_bf16_f32 v241, v200, v201
    v_cvt_pk_bf16_f32 v242, v202, v203
    v_cvt_pk_bf16_f32 v243, v204, 0
    v_cvt_pk_bf16_f32 v244, v205, v206
    v_cvt_pk_bf16_f32 v245, v207, v208
    v_cvt_pk_bf16_f32 v246, v209, v210
    v_cvt_pk_bf16_f32 v247, v211, 0
    ds_write_b128 v7, v[240:243]
    ds_write_b128 v7, v[244:247] offset:16
    v_pk_mul_f32 v[212:213], v[212:213], v[194:195] op_sel_hi:[1,0]
    v_pk_mul_f32 v[214:215], v[214:215], v[194:195] op_sel_hi:[1,0]
    v_pk_mul_f32 v[216:217], v[216:217], v[194:195] op_sel_hi:[1,0]
    v_pk_mul_f32 v[218:219], v[218:219], v[194:195] op_sel_hi:[1,0]
    v_pk_mul_f32 v[220:221], v[220:221], v[194:195] op_sel_hi:[1,0]
    v_pk_mul_f32 v[222:223], v[222:223], v[194:195] op_sel_hi:[1,0]
    v_pk_mul_f32 v[224:225], v[224:225], v[194:195] op_sel_hi:[1,0]
    v_cvt_pk_bf16_f32 v248, v212, v213
    v_cvt_pk_bf16_f32 v249, v214, v215
    v_cvt_pk_bf16_f32 v250, v216, v217
    v_cvt_pk_bf16_f32 v251, v218, 0
    ds_write_b128 v7, v[248:251] offset:64
    v_cvt_pk_bf16_f32 v252, v219, v220
    v_cvt_pk_bf16_f32 v253, v221, v222
    v_cvt_pk_bf16_f32 v254, v223, v224
    v_cvt_pk_bf16_f32 v255, v225, 0
    ds_write_b128 v7, v[252:255] offset:80
    s_waitcnt lgkmcnt(0)
L_m_common_2:
    s_barrier
    ds_read_b64_tr_b16 a[64:65], v6 offset:0
    ds_read_b64_tr_b16 a[66:67], v6 offset:3584
    ds_read_b64_tr_b16 a[80:81], v9 offset:0
    ds_read_b64_tr_b16 a[82:83], v9 offset:3584
    ds_read_b64_tr_b16 a[96:97], v9 offset:32
    ds_read_b64_tr_b16 a[98:99], v9 offset:3616
    ds_read_b64_tr_b16 a[68:69], v6 offset:7168
    ds_read_b64_tr_b16 a[70:71], v6 offset:10752
    ds_read_b64_tr_b16 a[84:85], v9 offset:7168
    ds_read_b64_tr_b16 a[86:87], v9 offset:10752
    ds_read_b64_tr_b16 a[100:101], v9 offset:7200
    ds_read_b64_tr_b16 a[102:103], v9 offset:10784
    ds_read_b64_tr_b16 a[72:73], v6 offset:14336
    ds_read_b64_tr_b16 a[74:75], v6 offset:17920
    ds_read_b64_tr_b16 a[88:89], v9 offset:14336
    ds_read_b64_tr_b16 a[90:91], v9 offset:17920
    ds_read_b64_tr_b16 a[104:105], v9 offset:14368
    ds_read_b64_tr_b16 a[106:107], v9 offset:17952
    s_waitcnt lgkmcnt(14)
    v_mfma_f32_16x16x32_bf16 v[192:195], a[80:83], a[64:67], 0
    s_waitcnt lgkmcnt(12)
    v_mfma_f32_16x16x32_bf16 v[196:199], a[96:99], a[64:67], 0
    ds_read_b64_tr_b16 a[76:77], v6 offset:21504
    ds_read_b64_tr_b16 a[78:79], v6 offset:25088
    ds_read_b64_tr_b16 a[92:93], v9 offset:21504
    ds_read_b64_tr_b16 a[94:95], v9 offset:25088
    ds_read_b64_tr_b16 a[108:109], v9 offset:21536
    ds_read_b64_tr_b16 a[110:111], v9 offset:25120
    s_waitcnt lgkmcnt(14)
    v_mfma_f32_16x16x32_bf16 v[192:195], a[84:87], a[68:71], v[192:195]
    s_waitcnt lgkmcnt(12)
    v_mfma_f32_16x16x32_bf16 v[196:199], a[100:103], a[68:71], v[196:199]
    ds_read_b128 a[0:3], v11 offset:0
    ds_read_b128 a[4:7], v11 offset:1024
    ds_read_b128 a[8:11], v11 offset:2048
    ds_read_b128 a[12:15], v11 offset:3072
    ds_read_b128 a[16:19], v11 offset:4096
    ds_read_b128 a[20:23], v11 offset:5120
    s_waitcnt lgkmcnt(14)
    v_mfma_f32_16x16x32_bf16 v[192:195], a[88:91], a[72:75], v[192:195]
    s_waitcnt lgkmcnt(12)
    v_mfma_f32_16x16x32_bf16 v[196:199], a[104:107], a[72:75], v[196:199]
    s_waitcnt lgkmcnt(8)
    v_mfma_f32_16x16x32_bf16 v[192:195], a[92:95], a[76:79], v[192:195]
    s_waitcnt lgkmcnt(6)
    v_mfma_f32_16x16x32_bf16 v[196:199], a[108:111], a[76:79], v[196:199]
    v_add_u32 v3, 57472, v15
    s_cmp_lt_u32 s8, 14
    s_cselect_b32 s12, -1, 0
    v_mov_b32 v204, s12
    v_lshlrev_b32 v205, 2, v1
    s_add_u32 s55, s53, 262144
    s_mov_b32 s13, 0xffff
    v_cvt_pk_bf16_f32 v200, v192, v193
    v_cvt_pk_bf16_f32 v202, v196, v197
    v_cvt_pk_bf16_f32 v201, v194, v195
    v_cvt_pk_bf16_f32 v203, v198, v199
    v_permlane16_swap_b32 v200, v202
    s_nop 0
    v_permlane16_swap_b32 v201, v203
    v_and_or_b32 v203, v203, s13, v13
    buffer_store_dwordx4 v[200:203], v2, s[20:23], s41 offen sc1
    s_cmp_eq_u32 s50, 0
    s_cbranch_scc0 L_m_md_13
    buffer_store_dword v204, v205, s[4:7], s55 offen
L_m_md_14:
    s_cmp_eq_u32 s40, 0
    s_cbranch_scc1 L_m_d2_15
    s_waitcnt lgkmcnt(5)
    v_mfma_f32_32x32x16_bf16 v[176:191], v[16:19], a[0:3], 0
    ds_read_b128 a[24:27], v11 offset:6144
    v_mov_b32 v220, -1
    v_mov_b32 v221, -1
    v_mov_b32 v222, -1
    v_mov_b32 v223, -1
    v_add_u32 v6, s18, v2
    s_waitcnt lgkmcnt(5)
    v_mfma_f32_32x32x16_bf16 v[176:191], v[20:23], a[4:7], v[176:191]
    ds_read_b128 a[28:31], v11 offset:7168
    s_mul_i32 s12, s11, 28672
    s_lshl_b32 s13, s19, 11
    s_add_u32 s12, s12, s13
    s_add_u32 s12, s12, 2625536
    s_waitcnt lgkmcnt(4)
    v_mfma_f32_32x32x16_bf16 v[176:191], v[24:27], a[8:11], v[176:191]
    ds_read_b128 a[0:3], v11 offset:8192
    s_cmp_eq_u32 s50, 0
    s_cbranch_scc0 L_m_md_17
    buffer_store_dwordx4 v[220:223], v6, s[4:7], s12 offen
    buffer_store_dwordx4 v[220:223], v6, s[4:7], s12 offen offset:1024
    buffer_store_dword v220, v205, s[4:7], s53 offen
L_m_md_18:
    v_mfma_f32_32x32x16_bf16 v[176:191], v[28:31], a[12:15], v[176:191]
    ds_read_b128 a[4:7], v11 offset:9216
    v_and_b32 v140, 60, v205
    v_lshrrev_b32 v139, 4, v1
    v_lshl_add_u32 v139, v139, 12, v140
    s_mul_i32 s16, s9, 960
    s_sub_u32 s16, s41, s16
    s_waitcnt lgkmcnt(4)
    v_mfma_f32_32x32x16_bf16 v[176:191], v[32:35], a[16:19], v[176:191]
    ds_read_b128 a[8:11], v11 offset:10240
    s_add_u32 s12, s15, 57472
    v_add_u32 v9, s12, v2
    v_mfma_f32_32x32x16_bf16 v[176:191], v[36:39], a[20:23], v[176:191]
    ds_read_b128 a[12:15], v11 offset:11264
    s_waitcnt vmcnt(9)
    ds_read_b32 v168, v9 offset:12
    ds_read_b32 v169, v9 offset:4108
    ds_read_b32 v170, v9 offset:8204
    ds_read_b32 v171, v9 offset:12300
    ds_read_b32 v172, v9 offset:16396
    ds_read_b32 v173, v9 offset:20492
    ds_read_b32 v174, v9 offset:24588
    s_waitcnt lgkmcnt(11)
    v_mfma_f32_32x32x16_bf16 v[176:191], v[40:43], a[24:27], v[176:191]
    ds_read_b128 a[16:19], v11 offset:12288
    v_mfma_f32_32x32x16_bf16 v[176:191], v[44:47], a[28:31], v[176:191]
    ds_read_b128 a[20:23], v11 offset:13312
    s_waitcnt lgkmcnt(11)
    v_mfma_f32_32x32x16_bf16 v[176:191], v[48:51], a[0:3], v[176:191]
    ds_read_b128 a[24:27], v11 offset:14336
    v_mfma_f32_32x32x16_bf16 v[176:191], v[52:55], a[4:7], v[176:191]
    ds_read_b128 a[28:31], v11 offset:15360
    s_waitcnt lgkmcnt(4)
    v_xor_b32 v174, v8, v174
    v_bitop3_b32 v173, v8, v173, v174 bitop3:0xbe
    v_bitop3_b32 v172, v8, v172, v173 bitop3:0xbe
    v_bitop3_b32 v171, v8, v171, v172 bitop3:0xbe
    v_bitop3_b32 v170, v8, v170, v171 bitop3:0xbe
    v_bitop3_b32 v169, v8, v169, v170 bitop3:0xbe
    v_bitop3_b32 v168, v8, v168, v169 bitop3:0xbe
    v_cmp_lt_u32 vcc, 0xffff, v168
    s_cbranch_vccnz L_m_rs_19
L_m_rb_20:
    v_mfma_f32_32x32x16_bf16 v[176:191], v[56:59], a[8:11], v[176:191]
    ds_read_b128 a[0:3], v11 offset:16384
    v_and_b32 v8, 15, v1
    v_lshrrev_b32 v7, 4, v1
    v_mul_u32_u24 v9, 144, v8
    v_and_b32 v7, 1, v7
    v_mfma_f32_32x32x16_bf16 v[176:191], v[60:63], a[12:15], v[176:191]
    ds_read_b128 a[4:7], v11 offset:17408
    v_lshl_add_u32 v9, v7, 5, v9
    v_lshl_add_u32 v9, v4, 4, v9
    s_and_b32 s13, s10, 1
    s_mul_i32 s13, s13, 2272
    s_waitcnt lgkmcnt(4)
    v_mfma_f32_32x32x16_bf16 v[176:191], v[64:67], a[16:19], v[176:191]
    ds_read_b128 a[8:11], v11 offset:18432
    s_lshl_b32 s12, s10, 5
    s_add_u32 s13, s13, s12
    s_add_u32 s13, s13, 151744
    v_add_u32 v9, s13, v9
    v_mfma_f32_32x32x16_bf16 v[176:191], v[68:71], a[20:23], v[176:191]
    ds_read_b128 a[12:15], v11 offset:19456
    v_mov_b32_dpp v136, v13 quad_perm:[0,0,0,0] row_mask:0xf bank_mask:0x1
    v_mov_b32 v137, 0
    v_mov_b32 v138, 0xffff0000
    v_mov_b32_dpp v136, v13 quad_perm:[1,1,1,1] row_mask:0xf bank_mask:0x2
    s_waitcnt lgkmcnt(4)
    v_mfma_f32_32x32x16_bf16 v[176:191], v[72:75], a[24:27], v[176:191]
    ds_read_b128 a[16:19], v11 offset:20480
    s_mov_b32 vcc_lo, 0x88888888
    s_mov_b32 vcc_hi, 0x88888888
    v_mov_b32_dpp v136, v13 quad_perm:[2,2,2,2] row_mask:0xf bank_mask:0x4
    v_cndmask_b32 v137, v137, v138, vcc
    v_mfma_f32_32x32x16_bf16 v[176:191], v[76:79], a[28:31], v[176:191]
    ds_read_b128 a[20:23], v11 offset:21504
    s_nop 0
    v_mov_b32_dpp v136, v13 quad_perm:[3,3,3,3] row_mask:0xf bank_mask:0x8
    s_lshl_b32 s14, s19, 16
    s_lshl_b32 s15, s10, 11
    s_waitcnt lgkmcnt(4)
    v_mfma_f32_32x32x16_bf16 v[176:191], v[80:83], a[0:3], v[176:191]
    ds_read_b128 a[24:27], v11 offset:22528
    s_add_u32 s14, s14, s15
    s_add_u32 s14, s14, 4096
    s_lshl_b32 s13, s9, 7
    s_sub_u32 s35, s46, s13
    v_mfma_f32_32x32x16_bf16 v[176:191], v[84:87], a[4:7], v[176:191]
    ds_read_b128 a[28:31], v11 offset:23552
    s_waitcnt lgkmcnt(4)
    v_mfma_f32_32x32x16_bf16 v[176:191], v[88:91], a[8:11], v[176:191]
    ds_read_b128 a[0:3], v11 offset:24576
    v_mfma_f32_32x32x16_bf16 v[176:191], v[92:95], a[12:15], v[176:191]
    ds_read_b128 a[4:7], v11 offset:25600
    s_waitcnt lgkmcnt(4)
    v_mfma_f32_32x32x16_bf16 v[176:191], v[96:99], a[16:19], v[176:191]
    ds_read_b128 a[8:11], v11 offset:26624
    v_mfma_f32_32x32x16_bf16 v[176:191], v[100:103], a[20:23], v[176:191]
    ds_read_b128 a[12:15], v11 offset:27648
    s_barrier
    s_waitcnt lgkmcnt(5)
    v_mfma_f32_32x32x16_bf16 v[176:191], v[104:107], a[24:27], v[176:191]
    ds_read_b64_tr_b16 a[16:17], v3 offset:0
    ds_read_b64_tr_b16 a[18:19], v3 offset:256
    v_add_u32 v3, v3, v14
    s_waitcnt lgkmcnt(6)
    v_mfma_f32_32x32x16_bf16 v[176:191], v[108:111], a[28:31], v[176:191]
    ds_read_b64_tr_b16 a[20:21], v3 offset:0
    ds_read_b64_tr_b16 a[22:23], v3 offset:256
    v_add_u32 v3, v3, v14
    s_waitcnt lgkmcnt(7)
    v_mfma_f32_32x32x16_bf16 v[176:191], v[112:115], a[0:3], v[176:191]
    ds_read_b64_tr_b16 a[24:25], v3 offset:0
    ds_read_b64_tr_b16 a[26:27], v3 offset:256
    v_add_u32 v3, v3, v14
    buffer_load_dword v128, v139, s[20:23], s16 offen offset:0 sc1
    buffer_load_dword v129, v139, s[20:23], s16 offen offset:1024 sc1
    buffer_load_dword v130, v139, s[20:23], s16 offen offset:2048 sc1
    buffer_load_dword v131, v139, s[20:23], s16 offen offset:3072 sc1
    v_accvgpr_read_b32 v141, a180
    buffer_load_dword v0, v141, s[4:7], 0 offen sc1
    s_waitcnt lgkmcnt(8)
    v_mfma_f32_32x32x16_bf16 v[176:191], v[116:119], a[4:7], v[176:191]
    ds_read_b64_tr_b16 a[28:29], v3 offset:0
    ds_read_b64_tr_b16 a[30:31], v3 offset:256
    v_add_u32 v3, v3, v14
    s_waitcnt lgkmcnt(9)
    v_mfma_f32_32x32x16_bf16 v[176:191], v[120:123], a[8:11], v[176:191]
    ds_read_b64_tr_b16 a[0:1], v3 offset:0
    ds_read_b64_tr_b16 a[2:3], v3 offset:256
    v_add_u32 v3, v3, v14
    s_waitcnt lgkmcnt(10)
    v_mfma_f32_32x32x16_bf16 v[176:191], v[124:127], a[12:15], v[176:191]
    ds_read_b64_tr_b16 a[4:5], v3 offset:0
    ds_read_b64_tr_b16 a[6:7], v3 offset:256
    v_add_u32 v3, v3, v14
    s_branch L_m_dj_16
L_m_d2_15:
    s_waitcnt lgkmcnt(5)
    v_mfma_f32_32x32x16_bf16 v[176:191], v[16:19], a[0:3], 0
    ds_read_b128 a[24:27], v11 offset:6144
    v_and_b32 v140, 60, v205
    v_lshrrev_b32 v139, 4, v1
    v_lshl_add_u32 v139, v139, 12, v140
    s_mul_i32 s16, s9, 960
    s_waitcnt lgkmcnt(5)
    v_mfma_f32_32x32x16_bf16 v[176:191], v[20:23], a[4:7], v[176:191]
    ds_read_b128 a[28:31], v11 offset:7168
    s_sub_u32 s16, s41, s16
    v_and_b32 v8, 15, v1
    v_lshrrev_b32 v7, 4, v1
    v_mul_u32_u24 v9, 144, v8
    s_waitcnt lgkmcnt(4)
    v_mfma_f32_32x32x16_bf16 v[176:191], v[24:27], a[8:11], v[176:191]
    ds_read_b128 a[0:3], v11 offset:8192
    v_and_b32 v7, 1, v7
    v_lshl_add_u32 v9, v7, 5, v9
    v_lshl_add_u32 v9, v4, 4, v9
    s_and_b32 s13, s10, 1
    v_mfma_f32_32x32x16_bf16 v[176:191], v[28:31], a[12:15], v[176:191]
    ds_read_b128 a[4:7], v11 offset:9216
    s_mul_i32 s13, s13, 2272
    s_lshl_b32 s12, s10, 5
    s_add_u32 s13, s13, s12
    s_add_u32 s13, s13, 151744
    s_waitcnt lgkmcnt(4)
    v_mfma_f32_32x32x16_bf16 v[176:191], v[32:35], a[16:19], v[176:191]
    ds_read_b128 a[8:11], v11 offset:10240
    v_add_u32 v9, s13, v9
    v_mov_b32_dpp v136, v13 quad_perm:[0,0,0,0] row_mask:0xf bank_mask:0x1
    v_mov_b32 v137, 0
    v_mov_b32 v138, 0xffff0000
    v_mfma_f32_32x32x16_bf16 v[176:191], v[36:39], a[20:23], v[176:191]
    ds_read_b128 a[12:15], v11 offset:11264
    v_mov_b32_dpp v136, v13 quad_perm:[1,1,1,1] row_mask:0xf bank_mask:0x2
    s_mov_b32 vcc_lo, 0x88888888
    s_mov_b32 vcc_hi, 0x88888888
    v_mov_b32_dpp v136, v13 quad_perm:[2,2,2,2] row_mask:0xf bank_mask:0x4
    s_waitcnt lgkmcnt(4)
    v_mfma_f32_32x32x16_bf16 v[176:191], v[40:43], a[24:27], v[176:191]
    ds_read_b128 a[16:19], v11 offset:12288
    v_cndmask_b32 v137, v137, v138, vcc
    s_nop 0
    v_mov_b32_dpp v136, v13 quad_perm:[3,3,3,3] row_mask:0xf bank_mask:0x8
    s_lshl_b32 s14, s19, 16
    v_mfma_f32_32x32x16_bf16 v[176:191], v[44:47], a[28:31], v[176:191]
    ds_read_b128 a[20:23], v11 offset:13312
    s_lshl_b32 s15, s10, 11
    s_add_u32 s14, s14, s15
    s_add_u32 s14, s14, 4096
    s_lshl_b32 s13, s9, 7
    s_waitcnt lgkmcnt(4)
    v_mfma_f32_32x32x16_bf16 v[176:191], v[48:51], a[0:3], v[176:191]
    ds_read_b128 a[24:27], v11 offset:14336
    s_sub_u32 s35, s46, s13
    v_mfma_f32_32x32x16_bf16 v[176:191], v[52:55], a[4:7], v[176:191]
    ds_read_b128 a[28:31], v11 offset:15360
    s_waitcnt lgkmcnt(4)
    v_mfma_f32_32x32x16_bf16 v[176:191], v[56:59], a[8:11], v[176:191]
    ds_read_b128 a[0:3], v11 offset:16384
    v_mfma_f32_32x32x16_bf16 v[176:191], v[60:63], a[12:15], v[176:191]
    ds_read_b128 a[4:7], v11 offset:17408
    s_waitcnt lgkmcnt(4)
    v_mfma_f32_32x32x16_bf16 v[176:191], v[64:67], a[16:19], v[176:191]
    ds_read_b128 a[8:11], v11 offset:18432
    v_mfma_f32_32x32x16_bf16 v[176:191], v[68:71], a[20:23], v[176:191]
    ds_read_b128 a[12:15], v11 offset:19456
    s_waitcnt lgkmcnt(4)
    v_mfma_f32_32x32x16_bf16 v[176:191], v[72:75], a[24:27], v[176:191]
    ds_read_b128 a[16:19], v11 offset:20480
    v_mfma_f32_32x32x16_bf16 v[176:191], v[76:79], a[28:31], v[176:191]
    ds_read_b128 a[20:23], v11 offset:21504
    s_waitcnt lgkmcnt(4)
    v_mfma_f32_32x32x16_bf16 v[176:191], v[80:83], a[0:3], v[176:191]
    ds_read_b128 a[24:27], v11 offset:22528
    v_mfma_f32_32x32x16_bf16 v[176:191], v[84:87], a[4:7], v[176:191]
    ds_read_b128 a[28:31], v11 offset:23552
    s_waitcnt lgkmcnt(4)
    v_mfma_f32_32x32x16_bf16 v[176:191], v[88:91], a[8:11], v[176:191]
    ds_read_b128 a[0:3], v11 offset:24576
    v_mfma_f32_32x32x16_bf16 v[176:191], v[92:95], a[12:15], v[176:191]
    ds_read_b128 a[4:7], v11 offset:25600
    s_waitcnt lgkmcnt(4)
    v_mfma_f32_32x32x16_bf16 v[176:191], v[96:99], a[16:19], v[176:191]
    ds_read_b128 a[8:11], v11 offset:26624
    v_mfma_f32_32x32x16_bf16 v[176:191], v[100:103], a[20:23], v[176:191]
    ds_read_b128 a[12:15], v11 offset:27648
    s_waitcnt lgkmcnt(5)
    v_mfma_f32_32x32x16_bf16 v[176:191], v[104:107], a[24:27], v[176:191]
    ds_read_b64_tr_b16 a[16:17], v3 offset:0
    ds_read_b64_tr_b16 a[18:19], v3 offset:256
    v_add_u32 v3, v3, v14
    buffer_load_dword v128, v139, s[20:23], s16 offen offset:0 sc1
    buffer_load_dword v129, v139, s[20:23], s16 offen offset:1024 sc1
    buffer_load_dword v130, v139, s[20:23], s16 offen offset:2048 sc1
    buffer_load_dword v131, v139, s[20:23], s16 offen offset:3072 sc1
    v_mov_b32 v141, 2147418112
    buffer_load_dword v0, v141, s[4:7], 0 offen sc1
    s_waitcnt lgkmcnt(6)
    v_mfma_f32_32x32x16_bf16 v[176:191], v[108:111], a[28:31], v[176:191]
    ds_read_b64_tr_b16 a[20:21], v3 offset:0
    ds_read_b64_tr_b16 a[22:23], v3 offset:256
    v_add_u32 v3, v3, v14
    s_waitcnt lgkmcnt(7)
    v_mfma_f32_32x32x16_bf16 v[176:191], v[112:115], a[0:3], v[176:191]
    ds_read_b64_tr_b16 a[24:25], v3 offset:0
    ds_read_b64_tr_b16 a[26:27], v3 offset:256
    v_add_u32 v3, v3, v14
    s_waitcnt lgkmcnt(8)
    v_mfma_f32_32x32x16_bf16 v[176:191], v[116:119], a[4:7], v[176:191]
    ds_read_b64_tr_b16 a[28:29], v3 offset:0
    ds_read_b64_tr_b16 a[30:31], v3 offset:256
    v_add_u32 v3, v3, v14
    s_waitcnt lgkmcnt(9)
    v_mfma_f32_32x32x16_bf16 v[176:191], v[120:123], a[8:11], v[176:191]
    ds_read_b64_tr_b16 a[0:1], v3 offset:0
    ds_read_b64_tr_b16 a[2:3], v3 offset:256
    v_add_u32 v3, v3, v14
    s_waitcnt lgkmcnt(10)
    v_mfma_f32_32x32x16_bf16 v[176:191], v[124:127], a[12:15], v[176:191]
    ds_read_b64_tr_b16 a[4:5], v3 offset:0
    ds_read_b64_tr_b16 a[6:7], v3 offset:256
    v_add_u32 v3, v3, v14
L_m_dj_16:
    s_waitcnt lgkmcnt(8)
    v_mfma_f32_32x32x16_bf16 v[160:175], a[16:19], v[16:19], 0
    s_barrier
    ds_read_b64_tr_b16 a[8:9], v3 offset:0
    ds_read_b64_tr_b16 a[10:11], v3 offset:256
    v_add_u32 v3, v3, v14
    v_mfma_f32_32x32x16_bf16 v[160:175], a[20:23], v[20:23], v[160:175]
    ds_read_b64_tr_b16 a[12:13], v3 offset:0
    ds_read_b64_tr_b16 a[14:15], v3 offset:256
    v_add_u32 v3, v3, v14
    v_mfma_f32_32x32x16_bf16 v[160:175], a[164:167], a[120:123], v[160:175]
    s_waitcnt lgkmcnt(8)
    v_mfma_f32_32x32x16_bf16 v[160:175], a[24:27], v[24:27], v[160:175]
    ds_read_b64_tr_b16 a[16:17], v3 offset:0
    ds_read_b64_tr_b16 a[18:19], v3 offset:256
    v_add_u32 v3, v3, v14
    v_mfma_f32_32x32x16_bf16 v[160:175], a[28:31], v[28:31], v[160:175]
    ds_read_b64_tr_b16 a[20:21], v3 offset:0
    ds_read_b64_tr_b16 a[22:23], v3 offset:256
    v_add_u32 v3, v3, v14
    s_waitcnt lgkmcnt(8)
    v_mfma_f32_32x32x16_bf16 v[160:175], a[0:3], v[32:35], v[160:175]
    ds_read_b64_tr_b16 a[24:25], v3 offset:0
    ds_read_b64_tr_b16 a[26:27], v3 offset:256
    v_add_u32 v3, v3, v14
    v_mfma_f32_32x32x16_bf16 v[160:175], a[4:7], v[36:39], v[160:175]
    ds_read_b64_tr_b16 a[28:29], v3 offset:0
    ds_read_b64_tr_b16 a[30:31], v3 offset:256
    v_add_u32 v3, v3, v14
    s_waitcnt lgkmcnt(8)
    v_mfma_f32_32x32x16_bf16 v[160:175], a[8:11], v[40:43], v[160:175]
    ds_read_b64_tr_b16 a[0:1], v3 offset:0
    ds_read_b64_tr_b16 a[2:3], v3 offset:256
    v_add_u32 v3, v3, v14
    v_mfma_f32_32x32x16_bf16 v[160:175], a[12:15], v[44:47], v[160:175]
    ds_read_b64_tr_b16 a[4:5], v3 offset:0
    ds_read_b64_tr_b16 a[6:7], v3 offset:256
    v_add_u32 v3, v3, v14
    s_waitcnt lgkmcnt(8)
    v_mfma_f32_32x32x16_bf16 v[160:175], a[16:19], v[48:51], v[160:175]
    ds_read_b64_tr_b16 a[8:9], v3 offset:0
    ds_read_b64_tr_b16 a[10:11], v3 offset:256
    v_add_u32 v3, v3, v14
    s_waitcnt vmcnt(4)
    v_xor_b32 v132, v136, v128
    s_waitcnt vmcnt(3)
    v_bitop3_b32 v132, v136, v129, v132 bitop3:0xbe
    s_waitcnt vmcnt(2)
    v_bitop3_b32 v132, v136, v130, v132 bitop3:0xbe
    s_waitcnt vmcnt(1)
    v_bitop3_b32 v132, v136, v131, v132 bitop3:0xbe
    v_and_b32 v132, v132, v137
    v_cmp_ne_u32 vcc, 0, v132
    s_cbranch_vccz L_m_rb_22
    s_mov_b32 s34, 0
L_m_rs_21:
    s_sleep 4
    buffer_load_dword v128, v139, s[20:23], s16 offen offset:0 sc1
    buffer_load_dword v129, v139, s[20:23], s16 offen offset:1024 sc1
    buffer_load_dword v130, v139, s[20:23], s16 offen offset:2048 sc1
    buffer_load_dword v131, v139, s[20:23], s16 offen offset:3072 sc1
    s_waitcnt vmcnt(3)
    v_xor_b32 v132, v136, v128
    s_waitcnt vmcnt(2)
    v_bitop3_b32 v132, v136, v129, v132 bitop3:0xbe
    s_waitcnt vmcnt(1)
    v_bitop3_b32 v132, v136, v130, v132 bitop3:0xbe
    s_waitcnt vmcnt(0)
    v_bitop3_b32 v132, v136, v131, v132 bitop3:0xbe
    v_and_b32 v132, v132, v137
    v_cmp_ne_u32 vcc, 0, v132
    s_cbranch_vccz L_m_rb_22
    s_add_u32 s34, s34, 1
    s_cmp_lt_u32 s34, 262144
    s_cbranch_scc1 L_m_rs_21
L_m_rb_22:
    v_mfma_f32_32x32x16_bf16 v[160:175], a[20:23], v[52:55], v[160:175]
    ds_read_b64_tr_b16 a[12:13], v3 offset:0
    ds_read_b64_tr_b16 a[14:15], v3 offset:256
    v_add_u32 v3, v3, v14
    v_lshlrev_b32 v132, 16, v128
    v_and_b32 v133, 0xffff0000, v128
    v_lshlrev_b32 v134, 16, v129
    v_and_b32 v135, 0xffff0000, v129
    v_add_f32 v132, v132, v134
    v_add_f32 v133, v133, v135
    v_lshlrev_b32 v134, 16, v130
    s_waitcnt lgkmcnt(8)
    v_mfma_f32_32x32x16_bf16 v[160:175], a[24:27], v[56:59], v[160:175]
    ds_read_b64_tr_b16 a[16:17], v3 offset:0
    ds_read_b64_tr_b16 a[18:19], v3 offset:256
    v_add_u32 v3, v3, v14
    v_and_b32 v135, 0xffff0000, v130
    v_add_f32 v132, v132, v134
    v_add_f32 v133, v133, v135
    v_lshlrev_b32 v134, 16, v131
    v_and_b32 v135, 0xffff0000, v131
    v_add_f32 v132, v132, v134
    v_add_f32 v133, v133, v135
    v_mfma_f32_32x32x16_bf16 v[160:175], a[28:31], v[60:63], v[160:175]
    ds_read_b64_tr_b16 a[20:21], v3 offset:0
    ds_read_b64_tr_b16 a[22:23], v3 offset:256
    v_add_u32 v3, v3, v14
    v_permlane32_swap_b32 v132, v133
    v_add_f32 v132, v132, v133
    v_mov_b32 v133, v132
    s_waitcnt lgkmcnt(8)
    v_mfma_f32_32x32x16_bf16 v[160:175], a[0:3], v[64:67], v[160:175]
    ds_read_b64_tr_b16 a[24:25], v3 offset:0
    ds_read_b64_tr_b16 a[26:27], v3 offset:256
    v_add_u32 v3, v3, v14
    v_permlane16_swap_b32 v132, v133
    v_add_f32 v132, v132, v133
    v_mov_b32 v133, v132
    v_mfma_f32_32x32x16_bf16 v[160:175], a[4:7], v[68:71], v[160:175]
    ds_read_b64_tr_b16 a[28:29], v3 offset:0
    ds_read_b64_tr_b16 a[30:31], v3 offset:256
    v_add_u32 v3, v3, v14
    v_permlane32_swap_b32 v132, v133
    v_cvt_pk_bf16_f32 v132, v132, v133
    v_bfi_b32 v132, v137, v136, v132
    s_mov_b64 exec, 0xffff
    buffer_store_dword v132, v140, s[20:23], s46 offen sc1
    s_mov_b64 exec, -1
    s_waitcnt lgkmcnt(8)
    v_mfma_f32_32x32x16_bf16 v[160:175], a[8:11], v[72:75], v[160:175]
    ds_read_b64_tr_b16 a[0:1], v3 offset:0
    ds_read_b64_tr_b16 a[2:3], v3 offset:256
    v_add_u32 v3, v3, v14
    s_add_u32 m0, s15, 86208
    s_add_u32 s12, s14, 0
    buffer_load_dwordx4 v2, s[4:7], s12 offen sc1 lds
    v_mfma_f32_32x32x16_bf16 v[160:175], a[12:15], v[76:79], v[160:175]
    ds_read_b64_tr_b16 a[4:5], v3 offset:0
    ds_read_b64_tr_b16 a[6:7], v3 offset:256
    v_add_u32 v3, v3, v14
    s_waitcnt lgkmcnt(8)
    v_mfma_f32_32x32x16_bf16 v[160:175], a[16:19], v[80:83], v[160:175]
    ds_read_b64_tr_b16 a[8:9], v3 offset:0
    ds_read_b64_tr_b16 a[10:11], v3 offset:256
    v_add_u32 v3, v3, v14
    buffer_load_dwordx4 v2, s[4:7], s12 offen offset:1024 sc1 lds
    v_mfma_f32_32x32x16_bf16 v[160:175], a[20:23], v[84:87], v[160:175]
    ds_read_b64_tr_b16 a[12:13], v3 offset:0
    ds_read_b64_tr_b16 a[14:15], v3 offset:256
    v_add_u32 v3, v3, v14
    s_waitcnt lgkmcnt(8)
    v_mfma_f32_32x32x16_bf16 v[160:175], a[24:27], v[88:91], v[160:175]
    ds_read_b64_tr_b16 a[16:17], v3 offset:0
    ds_read_b64_tr_b16 a[18:19], v3 offset:256
    v_add_u32 v3, v3, v14
    s_add_u32 m0, s15, 94400
    s_add_u32 s12, s14, 8192
    buffer_load_dwordx4 v2, s[4:7], s12 offen sc1 lds
    v_mfma_f32_32x32x16_bf16 v[160:175], a[28:31], v[92:95], v[160:175]
    ds_read_b64_tr_b16 a[20:21], v3 offset:0
    ds_read_b64_tr_b16 a[22:23], v3 offset:256
    v_add_u32 v3, v3, v14
    s_waitcnt lgkmcnt(8)
    v_mfma_f32_32x32x16_bf16 v[160:175], a[0:3], v[96:99], v[160:175]
    ds_read_b64_tr_b16 a[24:25], v3 offset:0
    ds_read_b64_tr_b16 a[26:27], v3 offset:256
    v_add_u32 v3, v3, v14
    buffer_load_dwordx4 v2, s[4:7], s12 offen offset:1024 sc1 lds
    v_mfma_f32_32x32x16_bf16 v[160:175], a[4:7], v[100:103], v[160:175]
    ds_read_b64_tr_b16 a[28:29], v3 offset:0
    ds_read_b64_tr_b16 a[30:31], v3 offset:256
    s_waitcnt lgkmcnt(8)
    v_mfma_f32_32x32x16_bf16 v[160:175], a[8:11], v[104:107], v[160:175]
    s_add_u32 m0, s15, 102592
    s_add_u32 s12, s14, 16384
    buffer_load_dwordx4 v2, s[4:7], s12 offen sc1 lds
    v_mfma_f32_32x32x16_bf16 v[160:175], a[12:15], v[108:111], v[160:175]
    s_waitcnt lgkmcnt(4)
    v_mfma_f32_32x32x16_bf16 v[160:175], a[16:19], v[112:115], v[160:175]
    buffer_load_dwordx4 v2, s[4:7], s12 offen offset:1024 sc1 lds
    v_mfma_f32_32x32x16_bf16 v[160:175], a[20:23], v[116:119], v[160:175]
    s_waitcnt lgkmcnt(0)
    v_mfma_f32_32x32x16_bf16 v[160:175], a[24:27], v[120:123], v[160:175]
    s_add_u32 m0, s15, 110784
    s_add_u32 s12, s14, 24576
    buffer_load_dwordx4 v2, s[4:7], s12 offen sc1 lds
    v_mfma_f32_32x32x16_bf16 v[160:175], a[28:31], v[124:127], v[160:175]
    s_nop 11
    v_cvt_pk_bf16_f32 v192, v160, v161
    v_cvt_pk_bf16_f32 v193, v162, v163
    v_cvt_pk_bf16_f32 v194, v164, v165
    v_cvt_pk_bf16_f32 v195, v166, v167
    v_cvt_pk_bf16_f32 v196, v168, v169
    v_cvt_pk_bf16_f32 v197, v170, v171
    v_cvt_pk_bf16_f32 v198, v172, v173
    v_cvt_pk_bf16_f32 v199, v174, v175
    v_mfma_f32_32x32x16_bf16 v[160:175], a[124:127], v[192:195], 0
    s_nop 0
    v_mfma_f32_32x32x16_bf16 v[160:175], a[128:131], v[196:199], v[160:175]
    v_and_b32 v7, 3, v5
    v_and_b32 v8, 8, v5
    v_lshl_add_u32 v7, v8, 1, v7
    v_and_b32 v8, 4, v5
    v_lshl_add_u32 v7, v8, 1, v7
    v_bfe_u32 v8, v5, 4, 1
    v_lshl_add_u32 v7, v8, 2, v7
    v_mul_u32_u24 v7, 144, v7
    v_lshl_add_u32 v7, v4, 5, v7
    v_add_u32 v7, 151744, v7
    v_and_b32 v6, 960, v2
    v_add_u32 v6, v6, v2
    v_max3_f32 v192, v160, v161, v162
    v_min3_f32 v194, v160, v161, v162
    v_max3_f32 v192, v192, v163, v164
    v_min3_f32 v194, v194, v163, v164
    buffer_load_dwordx4 v2, s[4:7], s12 offen offset:1024 sc1 lds
    v_max3_f32 v192, v192, v165, v166
    v_min3_f32 v194, v194, v165, v166
    v_max3_f32 v192, v192, v167, v168
    v_min3_f32 v194, v194, v167, v168
    v_max3_f32 v192, v192, v169, v170
    v_min3_f32 v194, v194, v169, v170
    v_max3_f32 v192, v192, v171, v172
    v_min3_f32 v194, v194, v171, v172
    s_add_u32 m0, s15, 118976
    s_add_u32 s12, s14, 32768
    buffer_load_dwordx4 v2, s[4:7], s12 offen sc1 lds
    v_max_f32 v192, v192, v173
    v_min_f32 v194, v194, v173
    v_mov_b32 v196, v192
    v_mov_b32 v197, v194
    s_nop 0
    v_permlane32_swap_b32 v196, v192
    v_permlane32_swap_b32 v197, v194
    v_max_f32 v192, v192, v196
    v_min_f32 v194, v194, v197
    buffer_load_dwordx4 v2, s[4:7], s12 offen offset:1024 sc1 lds
    v_mul_f32 v192, v192, v10
    v_mul_f32 v194, v194, v10
    v_pk_fma_f32 v[198:199], v[160:161], v[10:11], v[192:193] op_sel_hi:[1,0,0] neg_lo:[0,0,1] neg_hi:[0,0,1]
    v_pk_fma_f32 v[200:201], v[162:163], v[10:11], v[192:193] op_sel_hi:[1,0,0] neg_lo:[0,0,1] neg_hi:[0,0,1]
    v_pk_fma_f32 v[202:203], v[164:165], v[10:11], v[192:193] op_sel_hi:[1,0,0] neg_lo:[0,0,1] neg_hi:[0,0,1]
    v_pk_fma_f32 v[204:205], v[166:167], v[10:11], v[192:193] op_sel_hi:[1,0,0] neg_lo:[0,0,1] neg_hi:[0,0,1]
    v_pk_fma_f32 v[206:207], v[168:169], v[10:11], v[192:193] op_sel_hi:[1,0,0] neg_lo:[0,0,1] neg_hi:[0,0,1]
    v_pk_fma_f32 v[208:209], v[170:171], v[10:11], v[192:193] op_sel_hi:[1,0,0] neg_lo:[0,0,1] neg_hi:[0,0,1]
    s_add_u32 m0, s15, 127168
    s_add_u32 s12, s14, 40960
    buffer_load_dwordx4 v2, s[4:7], s12 offen sc1 lds
    v_pk_fma_f32 v[210:211], v[172:173], v[10:11], v[192:193] op_sel_hi:[1,0,0] neg_lo:[0,0,1] neg_hi:[0,0,1]
    v_pk_fma_f32 v[212:213], v[160:161], v[10:11], v[194:195] op_sel_hi:[1,0,0] neg_lo:[1,0,0] neg_hi:[1,0,0]
    v_pk_fma_f32 v[214:215], v[162:163], v[10:11], v[194:195] op_sel_hi:[1,0,0] neg_lo:[1,0,0] neg_hi:[1,0,0]
    v_pk_fma_f32 v[216:217], v[164:165], v[10:11], v[194:195] op_sel_hi:[1,0,0] neg_lo:[1,0,0] neg_hi:[1,0,0]
    v_pk_fma_f32 v[218:219], v[166:167], v[10:11], v[194:195] op_sel_hi:[1,0,0] neg_lo:[1,0,0] neg_hi:[1,0,0]
    v_pk_fma_f32 v[220:221], v[168:169], v[10:11], v[194:195] op_sel_hi:[1,0,0] neg_lo:[1,0,0] neg_hi:[1,0,0]
    v_pk_fma_f32 v[222:223], v[170:171], v[10:11], v[194:195] op_sel_hi:[1,0,0] neg_lo:[1,0,0] neg_hi:[1,0,0]
    v_pk_fma_f32 v[224:225], v[172:173], v[10:11], v[194:195] op_sel_hi:[1,0,0] neg_lo:[1,0,0] neg_hi:[1,0,0]
    buffer_load_dwordx4 v2, s[4:7], s12 offen offset:1024 sc1 lds
    v_exp_f32 v198, v198
    v_exp_f32 v199, v199
    v_exp_f32 v200, v200
    v_exp_f32 v201, v201
    v_exp_f32 v202, v202
    v_exp_f32 v203, v203
    v_exp_f32 v204, v204
    v_exp_f32 v205, v205
    s_add_u32 m0, s15, 135360
    s_add_u32 s12, s14, 49152
    buffer_load_dwordx4 v2, s[4:7], s12 offen sc1 lds
    v_exp_f32 v206, v206
    v_exp_f32 v207, v207
    v_exp_f32 v208, v208
    v_exp_f32 v209, v209
    v_exp_f32 v210, v210
    v_exp_f32 v211, v211
    v_exp_f32 v212, v212
    v_exp_f32 v213, v213
    buffer_load_dwordx4 v2, s[4:7], s12 offen offset:1024 sc1 lds
    v_exp_f32 v214, v214
    v_exp_f32 v215, v215
    v_exp_f32 v216, v216
    v_exp_f32 v217, v217
    v_exp_f32 v218, v218
    v_exp_f32 v219, v219
    v_exp_f32 v220, v220
    v_exp_f32 v221, v221
    buffer_load_dwordx4 v[128:131], v6, s[20:23], s35 offen sc1
    v_exp_f32 v222, v222
    v_exp_f32 v223, v223
    v_exp_f32 v224, v224
    v_exp_f32 v225, v225
    v_pk_add_f32 v[192:193], v[198:199], v[200:201]
    v_pk_add_f32 v[194:195], v[212:213], v[214:215]
    v_pk_add_f32 v[192:193], v[192:193], v[202:203]
    v_pk_add_f32 v[194:195], v[194:195], v[216:217]
    s_add_u32 m0, s15, 143552
    s_add_u32 s12, s14, 57344
    buffer_load_dwordx4 v2, s[4:7], s12 offen sc1 lds
    v_pk_add_f32 v[192:193], v[192:193], v[204:205]
    v_pk_add_f32 v[194:195], v[194:195], v[218:219]
    v_pk_add_f32 v[192:193], v[192:193], v[206:207]
    v_pk_add_f32 v[194:195], v[194:195], v[220:221]
    v_pk_add_f32 v[192:193], v[192:193], v[208:209]
    v_pk_add_f32 v[194:195], v[194:195], v[222:223]
    v_pk_add_f32 v[192:193], v[192:193], v[210:211]
    v_pk_add_f32 v[194:195], v[194:195], v[224:225]
    buffer_load_dwordx4 v2, s[4:7], s12 offen offset:1024 sc1 lds
    v_add_f32 v192, v192, v193
    v_add_f32 v194, v194, v195
    v_mov_b32 v196, v192
    v_mov_b32 v197, v194
    s_nop 0
    v_permlane32_swap_b32 v196, v192
    v_permlane32_swap_b32 v197, v194
    v_add_f32 v192, v192, v196
    v_add_f32 v194, v194, v197
    v_rcp_f32 v192, v192
    v_rcp_f32 v194, v194
    v_pk_mul_f32 v[198:199], v[198:199], v[192:193] op_sel_hi:[1,0]
    v_pk_mul_f32 v[200:201], v[200:201], v[192:193] op_sel_hi:[1,0]
    v_pk_mul_f32 v[202:203], v[202:203], v[192:193] op_sel_hi:[1,0]
    v_pk_mul_f32 v[204:205], v[204:205], v[192:193] op_sel_hi:[1,0]
    v_pk_mul_f32 v[206:207], v[206:207], v[192:193] op_sel_hi:[1,0]
    v_pk_mul_f32 v[208:209], v[208:209], v[192:193] op_sel_hi:[1,0]
    v_pk_mul_f32 v[210:211], v[210:211], v[192:193] op_sel_hi:[1,0]
    v_cvt_pk_bf16_f32 v240, v198, v199
    v_cvt_pk_bf16_f32 v241, v200, v201
    v_cvt_pk_bf16_f32 v242, v202, v203
    v_cvt_pk_bf16_f32 v243, v204, 0
    v_cvt_pk_bf16_f32 v244, v205, v206
    v_cvt_pk_bf16_f32 v245, v207, v208
    v_cvt_pk_bf16_f32 v246, v209, v210
    v_cvt_pk_bf16_f32 v247, v211, 0
    v_pk_mul_f32 v[212:213], v[212:213], v[194:195] op_sel_hi:[1,0]
    v_pk_mul_f32 v[214:215], v[214:215], v[194:195] op_sel_hi:[1,0]
    v_pk_mul_f32 v[216:217], v[216:217], v[194:195] op_sel_hi:[1,0]
    v_pk_mul_f32 v[218:219], v[218:219], v[194:195] op_sel_hi:[1,0]
    v_pk_mul_f32 v[220:221], v[220:221], v[194:195] op_sel_hi:[1,0]
    v_pk_mul_f32 v[222:223], v[222:223], v[194:195] op_sel_hi:[1,0]
    v_pk_mul_f32 v[224:225], v[224:225], v[194:195] op_sel_hi:[1,0]
    v_cvt_pk_bf16_f32 v248, v212, v213
    v_cvt_pk_bf16_f32 v249, v214, v215
    v_cvt_pk_bf16_f32 v250, v216, v217
    v_cvt_pk_bf16_f32 v251, v218, 0
    v_cvt_pk_bf16_f32 v252, v219, v220
    v_cvt_pk_bf16_f32 v253, v221, v222
    v_cvt_pk_bf16_f32 v254, v223, v224
    v_cvt_pk_bf16_f32 v255, v225, 0
    s_lshl_b32 s13, s11, 15
    s_add_u32 s13, s13, 4460544
    s_lshl_b32 s16, s8, 11
    s_add_u32 s16, s16, s13
    s_mov_b32 s17, 0xffff
    s_waitcnt vmcnt(2)
    v_xor_b32 v132, v13, v131
    v_cmp_lt_u32 vcc, s17, v132
    s_cbranch_vccz L_m_rb_24
    s_mov_b32 s34, 0
L_m_rs_23:
    s_sleep 4
    buffer_load_dwordx4 v[128:131], v6, s[20:23], s35 offen sc1
    s_waitcnt vmcnt(0)
    v_xor_b32 v132, v13, v131
    v_cmp_lt_u32 vcc, s17, v132
    s_cbranch_vccz L_m_rb_24
    s_add_u32 s34, s34, 1
    s_cmp_lt_u32 s34, 262144
    s_cbranch_scc1 L_m_rs_23
L_m_rb_24:
    ds_write_b128 v9, v[128:131]
    s_waitcnt vmcnt(0) lgkmcnt(0)
    s_barrier
    ds_read_b128 a[0:3], v7 offset:0
    ds_read_b128 a[4:7], v7 offset:16
    ds_read_b128 a[8:11], v7 offset:64
    ds_read_b128 a[12:15], v7 offset:80
    s_waitcnt lgkmcnt(3)
    v_mfma_f32_32x32x16_bf16 v[144:159], a[0:3], v[240:243], 0
    s_waitcnt lgkmcnt(2)
    v_mfma_f32_32x32x16_bf16 v[144:159], a[4:7], v[244:247], v[144:159]
    s_waitcnt lgkmcnt(1)
    v_mfma_f32_32x32x16_bf16 v[144:159], a[8:11], v[248:251], v[144:159]
    s_waitcnt lgkmcnt(0)
    v_mfma_f32_32x32x16_bf16 v[144:159], a[12:15], v[252:255], v[144:159]
    ds_read_b128 a[32:35], v11 offset:0
    ds_read_b128 a[36:39], v11 offset:1024
    ds_read_b128 a[40:43], v11 offset:2048
    ds_read_b128 a[44:47], v11 offset:3072
    ds_read_b128 a[48:51], v11 offset:4096
    ds_read_b128 a[52:55], v11 offset:5120
    s_nop 5
    v_add_f32 v12, 0x358637bd, v151
    v_rcp_f32 v12, v12
    s_cmp_eq_u32 s50, 0
    s_cbranch_scc0 L_m_md_25
    v_pk_mul_f32 v[144:145], v[144:145], v[12:13] op_sel_hi:[1,0]
    v_pk_mul_f32 v[146:147], v[146:147], v[12:13] op_sel_hi:[1,0]
    v_pk_mul_f32 v[148:149], v[148:149], v[12:13] op_sel_hi:[1,0]
    v_pk_mul_f32 v[150:151], v[150:151], v[12:13] op_sel_hi:[1,0]
    v_cvt_pk_bf16_f32 v192, v144, v145
    v_cvt_pk_bf16_f32 v193, v146, v147
    v_cvt_pk_bf16_f32 v194, v148, v149
    v_cvt_pk_bf16_f32 v195, v150, v151
    v_and_or_b32 v195, v195, s17, v13
    buffer_store_dwordx4 v[192:195], v2, s[4:7], s16 offen offset:0
    v_pk_mul_f32 v[152:153], v[152:153], v[12:13] op_sel_hi:[1,0]
    v_pk_mul_f32 v[154:155], v[154:155], v[12:13] op_sel_hi:[1,0]
    v_pk_mul_f32 v[156:157], v[156:157], v[12:13] op_sel_hi:[1,0]
    v_pk_mul_f32 v[158:159], v[158:159], v[12:13] op_sel_hi:[1,0]
    v_cvt_pk_bf16_f32 v196, v152, v153
    v_cvt_pk_bf16_f32 v197, v154, v155
    v_cvt_pk_bf16_f32 v198, v156, v157
    v_cvt_pk_bf16_f32 v199, v158, v159
    v_and_or_b32 v199, v199, s17, v13
    buffer_store_dwordx4 v[196:199], v2, s[4:7], s16 offen offset:1024
L_m_md_26:
    s_cmp_ge_u32 s8, 14
    s_cbranch_scc1 L_m_spare_27
    s_cmp_eq_u32 s40, 1
    s_cbranch_scc1 L_m_r1_28
    v_accvgpr_read_b32 v160, a140
    v_accvgpr_read_b32 v161, a141
    v_accvgpr_read_b32 v162, a142
    v_accvgpr_read_b32 v163, a143
    v_accvgpr_read_b32 v164, a144
    v_accvgpr_read_b32 v165, a145
    v_accvgpr_read_b32 v166, a146
    v_accvgpr_read_b32 v167, a147
    v_accvgpr_read_b32 v168, a148
    v_accvgpr_read_b32 v169, a149
    v_accvgpr_read_b32 v170, a150
    v_accvgpr_read_b32 v171, a151
    v_accvgpr_read_b32 v172, a152
    v_accvgpr_read_b32 v173, a153
    v_accvgpr_read_b32 v174, a154
    v_accvgpr_read_b32 v175, a155
    s_branch L_m_r2_29
L_m_r1_28:
    s_lshl_b32 s12, s19, 2
    s_set_gpr_idx_on s12, 1
    v_mov_b32 v208, v16
    v_mov_b32 v209, v17
    v_mov_b32 v210, v18
    v_mov_b32 v211, v19
    s_set_gpr_idx_off
    s_sub_u32 s12, 108, s12
    s_set_gpr_idx_on s12, 1
    v_mov_b32 v212, v16
    v_mov_b32 v213, v17
    v_mov_b32 v214, v18
    v_mov_b32 v215, v19
    s_set_gpr_idx_off
    s_add_u32 s12, s12, 4
    s_cmp_eq_u32 s19, 0
    s_cselect_b32 s12, 56, s12
    v_mov_b32 v216, v212
    s_mov_b32 exec_hi, 0
    s_set_gpr_idx_on s12, 1
    v_mov_b32 v216, v16
    s_set_gpr_idx_off
    s_mov_b32 exec_hi, -1
    v_permlane32_swap_b32 v212, v213
    v_permlane32_swap_b32 v214, v215
    v_lshlrev_b32 v160, 16, v208
    v_and_b32 v161, 0xffff0000, v208
    v_lshlrev_b32 v162, 16, v209
    v_and_b32 v163, 0xffff0000, v209
    v_lshlrev_b32 v164, 16, v210
    v_and_b32 v165, 0xffff0000, v210
    v_lshlrev_b32 v166, 16, v211
    v_and_b32 v167, 0xffff0000, v211
    v_permlane32_swap_b32 v213, v212
    v_permlane32_swap_b32 v215, v214
    v_and_b32 v168, 0xffff0000, v213
    v_lshlrev_b32 v169, 16, v212
    v_and_b32 v170, 0xffff0000, v212
    v_lshlrev_b32 v171, 16, v215
    v_and_b32 v172, 0xffff0000, v215
    v_lshlrev_b32 v173, 16, v214
    v_and_b32 v174, 0xffff0000, v214
    v_lshlrev_b32 v175, 16, v216
L_m_r2_29:
    v_and_b32 v7, 15, v1
    v_lshlrev_b32 v7, 4, v7
    v_lshl_add_u32 v7, v4, 2, v7
    v_bfe_u32 v6, v1, 4, 1
    v_lshl_add_u32 v7, v6, 3, v7
    s_lshl_b32 s33, s10, 7
    s_add_u32 s33, s33, 156352
    v_lshl_add_u32 v248, v5, 2, s33
    v_lshl_add_u32 v249, v4, 4, s33
    v_lshrrev_b32 v6, 1, v5
    v_mul_u32_u24 v6, 115072, v6
    s_bfe_u32 s33, s45, 0x10001
    v_xor_b32 v9, s33, v4
    v_lshl_add_u32 v6, v9, 5, v6
    v_and_b32 v9, 16, v2
    v_add_u32 v6, v6, v9
    s_add_u32 s16, s54, 262144
    s_lshl_b32 s33, s8, 13
    s_lshl_b32 s44, s45, 7
    s_add_u32 s44, s44, s33
    v_lshrrev_b32 v200, 1, v5
    v_and_b32 v9, 1, v5
    v_cvt_f32_u32 v200, v200
    v_cvt_f32_u32 v201, v9
    v_cvt_f32_u32 v202, s45
    v_mul_f32 v200, 0x3a000000, v200
    v_mul_f32 v201, 0x3e800000, v201
    v_cmp_eq_u32 s[32:33], 1, v5
    v_fmac_f32 v201, v200, v202
    v_mul_f32 v200, 0x42800000, v200
    v_lshlrev_b32 v9, 2, v4
    v_cvt_f32_u32 v9, v9
    v_cndmask_b32 v200, v200, 0.5, s[32:33]
    v_cndmask_b32 v201, v201, 0, s[32:33]
    v_fmac_f32 v201, v200, v9
    v_mov_b32 v204, v201
    v_fmamk_f32 v205, v200, 0x3f800000, v201
    v_cos_f32 v204, v204
    v_cos_f32 v205, v205
    s_add_u32 s35, s13, 0
    buffer_load_dwordx4 v[16:19], v2, s[4:7], s35 offen offset:0 sc1
    buffer_load_dwordx4 v[20:23], v2, s[4:7], s35 offen offset:1024 sc1
    buffer_load_dwordx4 v[24:27], v2, s[4:7], s35 offen offset:2048 sc1
    buffer_load_dwordx4 v[28:31], v2, s[4:7], s35 offen offset:3072 sc1
    s_add_u32 s35, s13, 4096
    buffer_load_dwordx4 v[32:35], v2, s[4:7], s35 offen offset:0 sc1
    buffer_load_dwordx4 v[36:39], v2, s[4:7], s35 offen offset:1024 sc1
    buffer_load_dwordx4 v[40:43], v2, s[4:7], s35 offen offset:2048 sc1
    buffer_load_dwordx4 v[44:47], v2, s[4:7], s35 offen offset:3072 sc1
    s_waitcnt vmcnt(4)
    v_xor_b32 v8, v13, v31
    v_bitop3_b32 v8, v13, v19, v8 bitop3:0xbe
    v_bitop3_b32 v8, v13, v23, v8 bitop3:0xbe
    v_bitop3_b32 v8, v13, v27, v8 bitop3:0xbe
    v_cmp_lt_u32 vcc, s17, v8
    s_cbranch_vccz L_m_rb_31
    s_mov_b32 s34, 0
L_m_rs_30:
    s_add_u32 s12, s13, 0
    buffer_load_dwordx4 v[16:19], v2, s[4:7], s12 offen offset:0 sc1
    buffer_load_dwordx4 v[20:23], v2, s[4:7], s12 offen offset:1024 sc1
    buffer_load_dwordx4 v[24:27], v2, s[4:7], s12 offen offset:2048 sc1
    buffer_load_dwordx4 v[28:31], v2, s[4:7], s12 offen offset:3072 sc1
    s_waitcnt vmcnt(0)
    v_xor_b32 v8, v13, v31
    v_bitop3_b32 v8, v13, v19, v8 bitop3:0xbe
    v_bitop3_b32 v8, v13, v23, v8 bitop3:0xbe
    v_bitop3_b32 v8, v13, v27, v8 bitop3:0xbe
    v_cmp_lt_u32 vcc, s17, v8
    s_cbranch_vccz L_m_ro_32
    s_add_u32 s34, s34, 1
    s_cmp_lt_u32 s34, 262144
    s_cbranch_scc1 L_m_rs_30
L_m_ro_32:
    s_add_u32 s12, s13, 4096
    buffer_load_dwordx4 v[32:35], v2, s[4:7], s12 offen offset:0 sc1
    buffer_load_dwordx4 v[36:39], v2, s[4:7], s12 offen offset:1024 sc1
    buffer_load_dwordx4 v[40:43], v2, s[4:7], s12 offen offset:2048 sc1
    buffer_load_dwordx4 v[44:47], v2, s[4:7], s12 offen offset:3072 sc1
L_m_rb_31:
    s_waitcnt lgkmcnt(4)
    v_mfma_f32_32x32x16_bf16 v[160:175], a[32:35], v[16:19], v[160:175]
    ds_read_b128 a[56:59], v11 offset:6144
    s_add_u32 s35, s13, 8192
    buffer_load_dwordx4 v[48:51], v2, s[4:7], s35 offen offset:0 sc1
    v_mfma_f32_32x32x16_bf16 v[176:191], v[16:19], a[36:39], v[176:191]
    ds_read_b128 a[60:63], v11 offset:7168
    buffer_load_dwordx4 v[52:55], v2, s[4:7], s35 offen offset:1024 sc1
    s_waitcnt lgkmcnt(4)
    v_mfma_f32_32x32x16_bf16 v[160:175], a[40:43], v[20:23], v[160:175]
    ds_read_b128 a[32:35], v11 offset:8192
    buffer_load_dwordx4 v[56:59], v2, s[4:7], s35 offen offset:2048 sc1
    v_mfma_f32_32x32x16_bf16 v[176:191], v[20:23], a[44:47], v[176:191]
    ds_read_b128 a[36:39], v11 offset:9216
    buffer_load_dwordx4 v[60:63], v2, s[4:7], s35 offen offset:3072 sc1
    s_waitcnt lgkmcnt(4)
    v_mfma_f32_32x32x16_bf16 v[160:175], a[48:51], v[24:27], v[160:175]
    ds_read_b128 a[40:43], v11 offset:10240
    s_add_u32 s35, s13, 12288
    buffer_load_dwordx4 v[64:67], v2, s[4:7], s35 offen offset:0 sc1
    v_mfma_f32_32x32x16_bf16 v[176:191], v[24:27], a[52:55], v[176:191]
    ds_read_b128 a[44:47], v11 offset:11264
    buffer_load_dwordx4 v[68:71], v2, s[4:7], s35 offen offset:1024 sc1
    s_waitcnt lgkmcnt(4)
    v_mfma_f32_32x32x16_bf16 v[160:175], a[56:59], v[28:31], v[160:175]
    ds_read_b128 a[48:51], v11 offset:12288
    s_waitcnt vmcnt(6)
    v_xor_b32 v8, v13, v47
    v_bitop3_b32 v8, v13, v35, v8 bitop3:0xbe
    v_bitop3_b32 v8, v13, v39, v8 bitop3:0xbe
    v_bitop3_b32 v8, v13, v43, v8 bitop3:0xbe
    v_cmp_lt_u32 vcc, s17, v8
    v_mfma_f32_32x32x16_bf16 v[176:191], v[28:31], a[60:63], v[176:191]
    ds_read_b128 a[52:55], v11 offset:13312
    s_cbranch_vccnz L_m_rs_33
L_m_rb_34:
    buffer_load_dwordx4 v[72:75], v2, s[4:7], s35 offen offset:2048 sc1
    s_waitcnt lgkmcnt(4)
    v_mfma_f32_32x32x16_bf16 v[160:175], a[32:35], v[32:35], v[160:175]
    ds_read_b128 a[56:59], v11 offset:14336
    buffer_load_dwordx4 v[76:79], v2, s[4:7], s35 offen offset:3072 sc1
    v_mfma_f32_32x32x16_bf16 v[176:191], v[32:35], a[36:39], v[176:191]
    ds_read_b128 a[60:63], v11 offset:15360
    v_fmamk_f32 v206, v200, 0x40000000, v201
    v_fmamk_f32 v207, v200, 0x40400000, v201
    s_waitcnt lgkmcnt(4)
    v_mfma_f32_32x32x16_bf16 v[160:175], a[40:43], v[36:39], v[160:175]
    ds_read_b128 a[32:35], v11 offset:16384
    s_add_u32 s35, s13, 16384
    buffer_load_dwordx4 v[80:83], v2, s[4:7], s35 offen offset:0 sc1
    v_mfma_f32_32x32x16_bf16 v[176:191], v[36:39], a[44:47], v[176:191]
    ds_read_b128 a[36:39], v11 offset:17408
    v_cos_f32 v206, v206
    v_cos_f32 v207, v207
    s_waitcnt lgkmcnt(4)
    v_mfma_f32_32x32x16_bf16 v[160:175], a[48:51], v[40:43], v[160:175]
    ds_read_b128 a[40:43], v11 offset:18432
    buffer_load_dwordx4 v[84:87], v2, s[4:7], s35 offen offset:1024 sc1
    v_mfma_f32_32x32x16_bf16 v[176:191], v[40:43], a[52:55], v[176:191]
    ds_read_b128 a[44:47], v11 offset:19456
    v_cvt_pk_bf16_f32 v204, v204, v205
    v_accvgpr_write_b32 a132, v204
    s_waitcnt lgkmcnt(4)
    v_mfma_f32_32x32x16_bf16 v[160:175], a[56:59], v[44:47], v[160:175]
    ds_read_b128 a[48:51], v11 offset:20480
    s_waitcnt vmcnt(6)
    v_xor_b32 v8, v13, v63
    v_bitop3_b32 v8, v13, v51, v8 bitop3:0xbe
    v_bitop3_b32 v8, v13, v55, v8 bitop3:0xbe
    v_bitop3_b32 v8, v13, v59, v8 bitop3:0xbe
    v_cmp_lt_u32 vcc, s17, v8
    v_mfma_f32_32x32x16_bf16 v[176:191], v[44:47], a[60:63], v[176:191]
    ds_read_b128 a[52:55], v11 offset:21504
    s_cbranch_vccnz L_m_rs_35
L_m_rb_36:
    buffer_load_dwordx4 v[88:91], v2, s[4:7], s35 offen offset:2048 sc1
    s_waitcnt lgkmcnt(4)
    v_mfma_f32_32x32x16_bf16 v[160:175], a[32:35], v[48:51], v[160:175]
    ds_read_b128 a[56:59], v11 offset:22528
    buffer_load_dwordx4 v[92:95], v2, s[4:7], s35 offen offset:3072 sc1
    v_mfma_f32_32x32x16_bf16 v[176:191], v[48:51], a[36:39], v[176:191]
    ds_read_b128 a[60:63], v11 offset:23552
    v_fmamk_f32 v204, v200, 0x41000000, v201
    v_fmamk_f32 v205, v200, 0x41100000, v201
    v_cos_f32 v204, v204
    s_waitcnt lgkmcnt(4)
    v_mfma_f32_32x32x16_bf16 v[160:175], a[40:43], v[52:55], v[160:175]
    ds_read_b128 a[32:35], v11 offset:24576
    s_add_u32 s35, s13, 20480
    buffer_load_dwordx4 v[96:99], v2, s[4:7], s35 offen offset:0 sc1
    v_mfma_f32_32x32x16_bf16 v[176:191], v[52:55], a[44:47], v[176:191]
    ds_read_b128 a[36:39], v11 offset:25600
    v_cos_f32 v205, v205
    s_waitcnt lgkmcnt(4)
    v_mfma_f32_32x32x16_bf16 v[160:175], a[48:51], v[56:59], v[160:175]
    ds_read_b128 a[40:43], v11 offset:26624
    buffer_load_dwordx4 v[100:103], v2, s[4:7], s35 offen offset:1024 sc1
    v_mfma_f32_32x32x16_bf16 v[176:191], v[56:59], a[52:55], v[176:191]
    ds_read_b128 a[44:47], v11 offset:27648
    v_cvt_pk_bf16_f32 v206, v206, v207
    v_accvgpr_write_b32 a133, v206
    v_fmamk_f32 v206, v200, 0x41200000, v201
    s_waitcnt lgkmcnt(4)
    v_mfma_f32_32x32x16_bf16 v[160:175], a[56:59], v[60:63], v[160:175]
    ds_read_b128 a[48:51], v11 offset:28672
    s_waitcnt vmcnt(6)
    v_xor_b32 v8, v13, v79
    v_bitop3_b32 v8, v13, v67, v8 bitop3:0xbe
    v_bitop3_b32 v8, v13, v71, v8 bitop3:0xbe
    v_bitop3_b32 v8, v13, v75, v8 bitop3:0xbe
    v_cmp_lt_u32 vcc, s17, v8
    v_mfma_f32_32x32x16_bf16 v[176:191], v[60:63], a[60:63], v[176:191]
    ds_read_b128 a[52:55], v11 offset:29696
    s_cbranch_vccnz L_m_rs_37
L_m_rb_38:
    buffer_load_dwordx4 v[104:107], v2, s[4:7], s35 offen offset:2048 sc1
    s_waitcnt lgkmcnt(4)
    v_mfma_f32_32x32x16_bf16 v[160:175], a[32:35], v[64:67], v[160:175]
    ds_read_b128 a[56:59], v11 offset:30720
    buffer_load_dwordx4 v[108:111], v2, s[4:7], s35 offen offset:3072 sc1
    v_mfma_f32_32x32x16_bf16 v[176:191], v[64:67], a[36:39], v[176:191]
    ds_read_b128 a[60:63], v11 offset:31744
    v_fmamk_f32 v207, v200, 0x41300000, v201
    v_cos_f32 v206, v206
    s_waitcnt lgkmcnt(4)
    v_mfma_f32_32x32x16_bf16 v[160:175], a[40:43], v[68:71], v[160:175]
    ds_read_b128 a[32:35], v11 offset:32768
    s_add_u32 s35, s13, 24576
    buffer_load_dwordx4 v[112:115], v2, s[4:7], s35 offen offset:0 sc1
    v_mfma_f32_32x32x16_bf16 v[176:191], v[68:71], a[44:47], v[176:191]
    ds_read_b128 a[36:39], v11 offset:34816
    v_cos_f32 v207, v207
    v_cvt_pk_bf16_f32 v204, v204, v205
    s_waitcnt lgkmcnt(4)
    v_mfma_f32_32x32x16_bf16 v[160:175], a[48:51], v[72:75], v[160:175]
    ds_read_b128 a[40:43], v11 offset:36864
    buffer_load_dwordx4 v[116:119], v2, s[4:7], s35 offen offset:1024 sc1
    v_mfma_f32_32x32x16_bf16 v[176:191], v[72:75], a[52:55], v[176:191]
    ds_read_b128 a[44:47], v11 offset:38912
    v_accvgpr_write_b32 a134, v204
    v_fmamk_f32 v204, v200, 0x41800000, v201
    v_fmamk_f32 v205, v200, 0x41880000, v201
    s_waitcnt lgkmcnt(4)
    v_mfma_f32_32x32x16_bf16 v[160:175], a[56:59], v[76:79], v[160:175]
    ds_read_b128 a[48:51], v11 offset:40960
    s_waitcnt vmcnt(6)
    v_xor_b32 v8, v13, v95
    v_bitop3_b32 v8, v13, v83, v8 bitop3:0xbe
    v_bitop3_b32 v8, v13, v87, v8 bitop3:0xbe
    v_bitop3_b32 v8, v13, v91, v8 bitop3:0xbe
    v_cmp_lt_u32 vcc, s17, v8
    v_mfma_f32_32x32x16_bf16 v[176:191], v[76:79], a[60:63], v[176:191]
    ds_read_b128 a[52:55], v11 offset:43008
    s_cbranch_vccnz L_m_rs_39
L_m_rb_40:
    buffer_load_dwordx4 v[120:123], v2, s[4:7], s35 offen offset:2048 sc1
    s_waitcnt lgkmcnt(4)
    v_mfma_f32_32x32x16_bf16 v[160:175], a[32:35], v[80:83], v[160:175]
    ds_read_b128 a[56:59], v11 offset:45056
    buffer_load_dwordx4 v[124:127], v2, s[4:7], s35 offen offset:3072 sc1
    v_mfma_f32_32x32x16_bf16 v[160:175], a[36:39], v[84:87], v[160:175]
    ds_read_b128 a[60:63], v11 offset:47104
    s_add_u32 s35, s13, 28672
    buffer_load_dwordx4 v[128:131], v2, s[4:7], s35 offen offset:0 sc1
    s_waitcnt lgkmcnt(4)
    v_mfma_f32_32x32x16_bf16 v[160:175], a[40:43], v[88:91], v[160:175]
    ds_read_b128 a[32:35], v11 offset:49152
    s_waitcnt vmcnt(5)
    v_xor_b32 v8, v13, v111
    v_bitop3_b32 v8, v13, v99, v8 bitop3:0xbe
    v_bitop3_b32 v8, v13, v103, v8 bitop3:0xbe
    v_bitop3_b32 v8, v13, v107, v8 bitop3:0xbe
    v_cmp_lt_u32 vcc, s17, v8
    v_mfma_f32_32x32x16_bf16 v[160:175], a[44:47], v[92:95], v[160:175]
    ds_read_b128 a[36:39], v11 offset:51200
    s_cbranch_vccnz L_m_rs_41
L_m_rb_42:
    buffer_load_dwordx4 v[132:135], v2, s[4:7], s35 offen offset:1024 sc1
    s_waitcnt lgkmcnt(4)
    v_mfma_f32_32x32x16_bf16 v[160:175], a[48:51], v[96:99], v[160:175]
    ds_read_b128 a[40:43], v11 offset:53248
    buffer_load_dwordx4 v[136:139], v2, s[4:7], s35 offen offset:2048 sc1
    v_mfma_f32_32x32x16_bf16 v[160:175], a[52:55], v[100:103], v[160:175]
    ds_read_b128 a[44:47], v11 offset:55296
    buffer_load_dwordx4 v[140:143], v2, s[4:7], s35 offen offset:3072 sc1
    s_waitcnt lgkmcnt(4)
    v_mfma_f32_32x32x16_bf16 v[160:175], a[56:59], v[104:107], v[160:175]
    ds_read_b128 a[48:51], v11 offset:57344
    s_waitcnt vmcnt(4)
    v_xor_b32 v8, v13, v127
    v_bitop3_b32 v8, v13, v115, v8 bitop3:0xbe
    v_bitop3_b32 v8, v13, v119, v8 bitop3:0xbe
    v_bitop3_b32 v8, v13, v123, v8 bitop3:0xbe
    v_cmp_lt_u32 vcc, s17, v8
    v_mfma_f32_32x32x16_bf16 v[160:175], a[60:63], v[108:111], v[160:175]
    ds_read_b128 a[52:55], v11 offset:59392
    s_cbranch_vccnz L_m_rs_43
L_m_rb_44:
    s_waitcnt lgkmcnt(4)
    v_mfma_f32_32x32x16_bf16 v[160:175], a[32:35], v[112:115], v[160:175]
    ds_read_b128 a[56:59], v11 offset:61440
    v_cos_f32 v204, v204
    v_cos_f32 v205, v205
    v_mfma_f32_32x32x16_bf16 v[160:175], a[36:39], v[116:119], v[160:175]
    ds_read_b128 a[60:63], v11 offset:63488
    v_cvt_pk_bf16_f32 v206, v206, v207
    v_accvgpr_write_b32 a135, v206
    s_waitcnt lgkmcnt(4)
    v_mfma_f32_32x32x16_bf16 v[160:175], a[40:43], v[120:123], v[160:175]
    ds_read_b128 a[32:35], v11 offset:33792
    s_waitcnt vmcnt(0)
    v_xor_b32 v8, v13, v143
    v_bitop3_b32 v8, v13, v131, v8 bitop3:0xbe
    v_bitop3_b32 v8, v13, v135, v8 bitop3:0xbe
    v_bitop3_b32 v8, v13, v139, v8 bitop3:0xbe
    v_cmp_lt_u32 vcc, s17, v8
    v_mfma_f32_32x32x16_bf16 v[160:175], a[44:47], v[124:127], v[160:175]
    ds_read_b128 a[36:39], v11 offset:35840
    s_cbranch_vccnz L_m_rs_45
L_m_rb_46:
    s_waitcnt lgkmcnt(4)
    v_mfma_f32_32x32x16_bf16 v[160:175], a[48:51], v[128:131], v[160:175]
    ds_read_b128 a[40:43], v11 offset:37888
    v_fmamk_f32 v206, v200, 0x41900000, v201
    v_fmamk_f32 v207, v200, 0x41980000, v201
    v_cos_f32 v206, v206
    v_mfma_f32_32x32x16_bf16 v[160:175], a[52:55], v[132:135], v[160:175]
    ds_read_b128 a[44:47], v11 offset:39936
    v_cos_f32 v207, v207
    s_waitcnt lgkmcnt(4)
    v_mfma_f32_32x32x16_bf16 v[160:175], a[56:59], v[136:139], v[160:175]
    ds_read_b128 a[48:51], v11 offset:41984
    v_cvt_pk_bf16_f32 v204, v204, v205
    v_accvgpr_write_b32 a136, v204
    v_fmamk_f32 v204, v200, 0x41c00000, v201
    v_mfma_f32_32x32x16_bf16 v[160:175], a[60:63], v[140:143], v[160:175]
    ds_read_b128 a[52:55], v11 offset:44032
    v_fmamk_f32 v205, v200, 0x41c80000, v201
    v_cos_f32 v204, v204
    s_nop 8
    v_pk_add_f32 v[192:193], v[160:161], v[162:163]
    v_pk_mul_f32 v[194:195], v[160:161], v[160:161]
    v_pk_fma_f32 v[194:195], v[162:163], v[162:163], v[194:195]
    v_pk_add_f32 v[192:193], v[192:193], v[164:165]
    v_pk_fma_f32 v[194:195], v[164:165], v[164:165], v[194:195]
    v_pk_add_f32 v[192:193], v[192:193], v[166:167]
    v_pk_fma_f32 v[194:195], v[166:167], v[166:167], v[194:195]
    v_pk_add_f32 v[192:193], v[192:193], v[168:169]
    v_pk_fma_f32 v[194:195], v[168:169], v[168:169], v[194:195]
    v_pk_add_f32 v[192:193], v[192:193], v[170:171]
    v_pk_fma_f32 v[194:195], v[170:171], v[170:171], v[194:195]
    v_pk_add_f32 v[192:193], v[192:193], v[172:173]
    v_pk_fma_f32 v[194:195], v[172:173], v[172:173], v[194:195]
    v_pk_add_f32 v[192:193], v[192:193], v[174:175]
    v_pk_fma_f32 v[194:195], v[174:175], v[174:175], v[194:195]
    v_add_f32 v192, v192, v193
    v_add_f32 v194, v194, v195
    s_waitcnt lgkmcnt(4)
    v_mfma_f32_32x32x16_bf16 v[176:191], v[80:83], a[32:35], v[176:191]
    ds_read_b128 a[56:59], v11 offset:46080
    v_permlane32_swap_b32 v192, v194
    v_add_f32 v192, v192, v194
    s_cmp_eq_u32 s50, 0
    s_cbranch_scc0 L_m_md_47
    buffer_store_dword v192, v7, s[4:7], s55 offen
L_m_md_48:
    v_mfma_f32_32x32x16_bf16 v[176:191], v[84:87], a[36:39], v[176:191]
    ds_read_b128 a[60:63], v11 offset:48128
    v_cos_f32 v205, v205
    v_cvt_pk_bf16_f32 v206, v206, v207
    v_accvgpr_write_b32 a137, v206
    s_waitcnt lgkmcnt(4)
    v_mfma_f32_32x32x16_bf16 v[176:191], v[88:91], a[40:43], v[176:191]
    ds_read_b128 a[32:35], v11 offset:50176
    v_fmamk_f32 v206, v200, 0x41d00000, v201
    v_fmamk_f32 v207, v200, 0x41d80000, v201
    v_cos_f32 v206, v206
    v_mfma_f32_32x32x16_bf16 v[176:191], v[92:95], a[44:47], v[176:191]
    ds_read_b128 a[36:39], v11 offset:52224
    v_cos_f32 v207, v207
    v_cvt_pk_bf16_f32 v204, v204, v205
    v_accvgpr_write_b32 a138, v204
    s_waitcnt lgkmcnt(4)
    v_mfma_f32_32x32x16_bf16 v[176:191], v[96:99], a[48:51], v[176:191]
    ds_read_b128 a[40:43], v11 offset:54272
    v_cvt_pk_bf16_f32 v206, v206, v207
    v_accvgpr_write_b32 a139, v206
    v_mfma_f32_32x32x16_bf16 v[176:191], v[100:103], a[52:55], v[176:191]
    ds_read_b128 a[44:47], v11 offset:56320
    s_waitcnt lgkmcnt(4)
    v_mfma_f32_32x32x16_bf16 v[176:191], v[104:107], a[56:59], v[176:191]
    ds_read_b128 a[48:51], v11 offset:58368
    v_mfma_f32_32x32x16_bf16 v[176:191], v[108:111], a[60:63], v[176:191]
    ds_read_b128 a[52:55], v11 offset:60416
    s_waitcnt lgkmcnt(4)
    v_mfma_f32_32x32x16_bf16 v[176:191], v[112:115], a[32:35], v[176:191]
    ds_read_b128 a[56:59], v11 offset:62464
    v_mfma_f32_32x32x16_bf16 v[176:191], v[116:119], a[36:39], v[176:191]
    ds_read_b128 a[60:63], v11 offset:64512
    s_waitcnt lgkmcnt(4)
    v_mfma_f32_32x32x16_bf16 v[176:191], v[120:123], a[40:43], v[176:191]
    v_mfma_f32_32x32x16_bf16 v[176:191], v[124:127], a[44:47], v[176:191]
    s_waitcnt lgkmcnt(2)
    v_mfma_f32_32x32x16_bf16 v[176:191], v[128:131], a[48:51], v[176:191]
    v_mfma_f32_32x32x16_bf16 v[176:191], v[132:135], a[52:55], v[176:191]
    s_waitcnt lgkmcnt(0)
    v_mfma_f32_32x32x16_bf16 v[176:191], v[136:139], a[56:59], v[176:191]
    v_mfma_f32_32x32x16_bf16 v[176:191], v[140:143], a[60:63], v[176:191]
    s_barrier
    buffer_load_dwordx4 v[16:19], v2, s[4:7], s16 offen offset:0 sc1
    buffer_load_dwordx4 v[20:23], v2, s[4:7], s16 offen offset:1024 sc1
    buffer_load_dwordx4 v[24:27], v2, s[4:7], s16 offen offset:2048 sc1
    buffer_load_dwordx4 v[28:31], v2, s[4:7], s16 offen offset:3072 sc1
    s_waitcnt vmcnt(2)
    v_add_f32 v16, v16, v20
    v_add_f32 v17, v17, v21
    v_add_f32 v18, v18, v22
    v_add_f32 v19, v19, v23
    s_waitcnt vmcnt(0)
    v_add_f32 v24, v24, v28
    v_add_f32 v25, v25, v29
    v_add_f32 v26, v26, v30
    v_add_f32 v27, v27, v31
    v_add_f32 v16, v16, v24
    v_add_f32 v17, v17, v25
    v_add_f32 v18, v18, v26
    v_add_f32 v19, v19, v27
    v_permlane32_swap_b32 v16, v17
    s_nop 0
    v_permlane32_swap_b32 v18, v19
    v_add_f32 v16, v16, v17
    v_add_f32 v18, v18, v19
    s_nop 1
    v_permlane16_swap_b32 v16, v18
    v_add_f32 v16, v16, v18
    v_cmp_u_f32 vcc, v16, v16
    v_mov_b32 v17, v16
    v_mov_b32 v192, 0x3727c5ac
    s_cbranch_vccz L_m_rb_50
    s_mov_b32 s34, 0
L_m_rs_49:
    buffer_load_dwordx4 v[16:19], v2, s[4:7], s16 offen offset:0 sc1
    buffer_load_dwordx4 v[20:23], v2, s[4:7], s16 offen offset:1024 sc1
    buffer_load_dwordx4 v[24:27], v2, s[4:7], s16 offen offset:2048 sc1
    buffer_load_dwordx4 v[28:31], v2, s[4:7], s16 offen offset:3072 sc1
    s_waitcnt vmcnt(2)
    v_add_f32 v16, v16, v20
    v_add_f32 v17, v17, v21
    v_add_f32 v18, v18, v22
    v_add_f32 v19, v19, v23
    s_waitcnt vmcnt(0)
    v_add_f32 v24, v24, v28
    v_add_f32 v25, v25, v29
    v_add_f32 v26, v26, v30
    v_add_f32 v27, v27, v31
    v_add_f32 v16, v16, v24
    v_add_f32 v17, v17, v25
    v_add_f32 v18, v18, v26
    v_add_f32 v19, v19, v27
    v_permlane32_swap_b32 v16, v17
    s_nop 0
    v_permlane32_swap_b32 v18, v19
    v_add_f32 v16, v16, v17
    v_add_f32 v18, v18, v19
    s_nop 1
    v_permlane16_swap_b32 v16, v18
    v_add_f32 v16, v16, v18
    v_cmp_u_f32 vcc, v16, v16
    v_mov_b32 v17, v16
    v_mov_b32 v192, 0x3727c5ac
    s_cbranch_vccz L_m_rb_50
    s_add_u32 s34, s34, 1
    s_cmp_lt_u32 s34, 65536
    s_cbranch_scc1 L_m_rs_49
L_m_rb_50:
    v_permlane32_swap_b32 v16, v17
    v_mul_f32 v16, 0x3b124925, v16
    v_fmac_f32 v192, 0x3b124925, v17
    v_fma_f32 v192, -v16, v16, v192
    v_rsq_f32 v192, v192
    s_nop 0
    ds_write_b32 v248, v192
    ds_read_b128 v[196:199], v249 offset:0
    ds_read_b128 v[200:203], v249 offset:32
    ds_read_b128 v[204:207], v249 offset:64
    ds_read_b128 v[208:211], v249 offset:96
    s_waitcnt lgkmcnt(3)
    v_pk_mul_f32 v[176:177], v[176:177], v[196:197]
    v_cvt_pk_bf16_f32 v240, v176, v177
    v_pk_mul_f32 v[178:179], v[178:179], v[198:199]
    v_cvt_pk_bf16_f32 v241, v178, v179
    s_waitcnt lgkmcnt(2)
    v_pk_mul_f32 v[180:181], v[180:181], v[200:201]
    v_cvt_pk_bf16_f32 v242, v180, v181
    v_pk_mul_f32 v[182:183], v[182:183], v[202:203]
    v_cvt_pk_bf16_f32 v243, v182, v183
    s_waitcnt lgkmcnt(1)
    v_pk_mul_f32 v[184:185], v[184:185], v[204:205]
    v_cvt_pk_bf16_f32 v244, v184, v185
    v_pk_mul_f32 v[186:187], v[186:187], v[206:207]
    v_cvt_pk_bf16_f32 v245, v186, v187
    s_waitcnt lgkmcnt(0)
    v_pk_mul_f32 v[188:189], v[188:189], v[208:209]
    v_cvt_pk_bf16_f32 v246, v188, v189
    v_pk_mul_f32 v[190:191], v[190:191], v[210:211]
    v_cvt_pk_bf16_f32 v247, v190, v191
    v_mfma_f32_32x32x16_bf16 v[144:159], v[240:243], a[132:135], 0
    s_nop 0
    v_mfma_f32_32x32x16_bf16 v[144:159], v[244:247], a[136:139], v[144:159]
    v_lshlrev_b32 v9, 2, v5
    s_and_b32 s12, s10, 1
    s_lshl_b32 s12, s12, 1
    s_cmp_eq_u32 s9, 0
    s_cselect_b32 s13, 1, 2
    s_cmp_lt_u32 s10, 2
    s_cselect_b32 s13, 0, s13
    s_cselect_b32 s16, 1.0, -1.0
    s_add_u32 s12, s12, s13
    v_add_u32 v9, s12, v9
    v_cvt_f32_u32 v9, v9
    s_nop 0
    v_cvt_pk_bf16_f32 v192, v144, v145
    v_cvt_pk_bf16_f32 v193, v146, v147
    v_cvt_pk_bf16_f32 v194, v148, v149
    v_cvt_pk_bf16_f32 v195, v150, v151
    buffer_store_dwordx4 v[192:195], v6, s[20:23], s44 offen offset:0 sc1
    v_cvt_pk_bf16_f32 v196, v152, v153
    v_cvt_pk_bf16_f32 v197, v154, v155
    v_cvt_pk_bf16_f32 v198, v156, v157
    v_cvt_pk_bf16_f32 v199, v158, v159
    buffer_store_dwordx4 v[196:199], v6, s[20:23], s44 offen offset:64 sc1
    v_mul_f32 v9, 0x3c000000, v9
    v_lshlrev_b32 v8, 3, v4
    v_cvt_f32_u32 v8, v8
    v_mul_f32 v8, v9, v8
    s_cmp_eq_u32 s9, 0
    s_cselect_b32 s16, 0, s16
    s_mul_i32 s14, s9, 115072
    s_lshl_b32 s12, s8, 13
    s_add_u32 s14, s14, s12
    s_lshl_b32 s12, s10, 11
    s_add_u32 s14, s14, s12
    s_add_u32 s12, s12, 114880
    v_add_u32 v3, s12, v2
    v_mov_b32 v208, v8
    v_fmamk_f32 v209, v9, 0x3f800000, v8
    v_cos_f32 v210, v208
    v_cos_f32 v211, v209
    v_sin_f32 v212, v208
    v_sin_f32 v213, v209
    v_cvt_pk_bf16_f32 v32, v210, v211
    v_cvt_pk_bf16_f32 v48, v212, v213
    v_fmamk_f32 v216, v9, 0x40000000, v8
    v_fmamk_f32 v217, v9, 0x40400000, v8
    v_cos_f32 v218, v216
    v_cos_f32 v219, v217
    v_sin_f32 v220, v216
    v_sin_f32 v221, v217
    v_cvt_pk_bf16_f32 v33, v218, v219
    v_cvt_pk_bf16_f32 v49, v220, v221
    v_fmamk_f32 v208, v9, 0x40800000, v8
    v_fmamk_f32 v209, v9, 0x40a00000, v8
    v_cos_f32 v210, v208
    v_cos_f32 v211, v209
    v_sin_f32 v212, v208
    v_sin_f32 v213, v209
    v_cvt_pk_bf16_f32 v34, v210, v211
    v_cvt_pk_bf16_f32 v50, v212, v213
    v_fmamk_f32 v216, v9, 0x40c00000, v8
    v_fmamk_f32 v217, v9, 0x40e00000, v8
    v_cos_f32 v218, v216
    v_cos_f32 v219, v217
    v_sin_f32 v220, v216
    v_sin_f32 v221, v217
    v_cvt_pk_bf16_f32 v35, v218, v219
    v_cvt_pk_bf16_f32 v51, v220, v221
    v_fmamk_f32 v208, v9, 0x41800000, v8
    v_fmamk_f32 v209, v9, 0x41880000, v8
    v_cos_f32 v210, v208
    v_cos_f32 v211, v209
    v_sin_f32 v212, v208
    v_sin_f32 v213, v209
    v_cvt_pk_bf16_f32 v36, v210, v211
    v_cvt_pk_bf16_f32 v52, v212, v213
    v_fmamk_f32 v216, v9, 0x41900000, v8
    v_fmamk_f32 v217, v9, 0x41980000, v8
    v_cos_f32 v218, v216
    v_cos_f32 v219, v217
    v_sin_f32 v220, v216
    v_sin_f32 v221, v217
    v_cvt_pk_bf16_f32 v37, v218, v219
    v_cvt_pk_bf16_f32 v53, v220, v221
    v_fmamk_f32 v208, v9, 0x41a00000, v8
    v_fmamk_f32 v209, v9, 0x41a80000, v8
    v_cos_f32 v210, v208
    v_cos_f32 v211, v209
    v_sin_f32 v212, v208
    v_sin_f32 v213, v209
    v_cvt_pk_bf16_f32 v38, v210, v211
    v_cvt_pk_bf16_f32 v54, v212, v213
    v_fmamk_f32 v216, v9, 0x41b00000, v8
    v_fmamk_f32 v217, v9, 0x41b80000, v8
    v_cos_f32 v218, v216
    v_cos_f32 v219, v217
    v_sin_f32 v220, v216
    v_sin_f32 v221, v217
    v_cvt_pk_bf16_f32 v39, v218, v219
    v_cvt_pk_bf16_f32 v55, v220, v221
    v_fmamk_f32 v208, v9, 0x42000000, v8
    v_fmamk_f32 v209, v9, 0x42040000, v8
    v_cos_f32 v210, v208
    v_cos_f32 v211, v209
    v_sin_f32 v212, v208
    v_sin_f32 v213, v209
    v_cvt_pk_bf16_f32 v40, v210, v211
    v_cvt_pk_bf16_f32 v56, v212, v213
    v_fmamk_f32 v216, v9, 0x42080000, v8
    v_fmamk_f32 v217, v9, 0x420c0000, v8
    v_cos_f32 v218, v216
    v_cos_f32 v219, v217
    v_sin_f32 v220, v216
    v_sin_f32 v221, v217
    v_cvt_pk_bf16_f32 v41, v218, v219
    v_cvt_pk_bf16_f32 v57, v220, v221
    v_fmamk_f32 v208, v9, 0x42100000, v8
    v_fmamk_f32 v209, v9, 0x42140000, v8
    v_cos_f32 v210, v208
    v_cos_f32 v211, v209
    v_sin_f32 v212, v208
    v_sin_f32 v213, v209
    v_cvt_pk_bf16_f32 v42, v210, v211
    v_cvt_pk_bf16_f32 v58, v212, v213
    v_fmamk_f32 v216, v9, 0x42180000, v8
    v_fmamk_f32 v217, v9, 0x421c0000, v8
    v_cos_f32 v218, v216
    v_cos_f32 v219, v217
    v_sin_f32 v220, v216
    v_sin_f32 v221, v217
    v_cvt_pk_bf16_f32 v43, v218, v219
    v_cvt_pk_bf16_f32 v59, v220, v221
    v_fmamk_f32 v208, v9, 0x42400000, v8
    v_fmamk_f32 v209, v9, 0x42440000, v8
    v_cos_f32 v210, v208
    v_cos_f32 v211, v209
    v_sin_f32 v212, v208
    v_sin_f32 v213, v209
    v_cvt_pk_bf16_f32 v44, v210, v211
    v_cvt_pk_bf16_f32 v60, v212, v213
    v_fmamk_f32 v216, v9, 0x42480000, v8
    v_fmamk_f32 v217, v9, 0x424c0000, v8
    v_cos_f32 v218, v216
    v_cos_f32 v219, v217
    v_sin_f32 v220, v216
    v_sin_f32 v221, v217
    v_cvt_pk_bf16_f32 v45, v218, v219
    v_cvt_pk_bf16_f32 v61, v220, v221
    v_fmamk_f32 v208, v9, 0x42500000, v8
    v_fmamk_f32 v209, v9, 0x42540000, v8
    v_cos_f32 v210, v208
    v_cos_f32 v211, v209
    v_sin_f32 v212, v208
    v_sin_f32 v213, v209
    v_cvt_pk_bf16_f32 v46, v210, v211
    v_cvt_pk_bf16_f32 v62, v212, v213
    v_fmamk_f32 v216, v9, 0x42580000, v8
    v_fmamk_f32 v217, v9, 0x425c0000, v8
    v_cos_f32 v218, v216
    v_cos_f32 v219, v217
    v_sin_f32 v220, v216
    v_sin_f32 v221, v217
    v_cvt_pk_bf16_f32 v47, v218, v219
    v_cvt_pk_bf16_f32 v63, v220, v221
    v_bfe_u32 v6, v1, 2, 2
    v_lshl_add_u32 v6, v4, 3, v6
    v_lshlrev_b32 v6, 7, v6
    v_and_b32 v8, 1, v1
    v_lshl_add_u32 v6, v8, 6, v6
    v_bfe_u32 v8, v1, 4, 1
    v_mad_u32_u24 v6, v8, 48, v6
    v_and_b32 v8, 2, v1
    v_lshl_add_u32 v6, v8, 2, v6
    v_and_b32 v8, 8, v1
    v_lshlrev_b32 v8, 2, v8
    s_and_b32 s13, s13, 1
    s_lshl_b32 s13, s13, 4
    v_xor_b32 v8, s13, v8
    v_xor_b32 v6, v6, v8
    v_add_u32 v6, 114880, v6
    v_xor_b32 v8, 32, v6
    v_lshlrev_b32 v9, 4, v5
    v_lshl_add_u32 v9, v4, 10, v9
    s_mul_i32 s13, s11, 28672
    s_add_u32 s13, s13, 2625536
    s_lshl_b32 s12, s8, 11
    s_add_u32 s44, s13, s12
    v_mov_b32 v192, v160
    v_and_b32 v10, 30, v5
    v_add_u32 v10, v10, v4
    v_xor_b32 v11, 1, v10
    s_lshl_b32 s12, s8, 6
    s_sub_u32 s12, 866, s12
    v_mul_lo_u32 v12, v4, s12
    s_lshl_b32 s12, s8, 5
    v_and_b32 v193, 16, v2
    v_add3_u32 v12, v12, v193, s12
    v_mov_b32 v193, 57344
    v_mad_u32_u24 v10, v10, v193, v12
    v_mad_u32_u24 v11, v11, v193, v12
    buffer_load_dwordx4 v[16:19], v2, s[20:23], s14 offen offset:0 sc1
    buffer_load_dwordx4 v[20:23], v2, s[20:23], s14 offen offset:1024 sc1
    s_cmp_eq_u32 s40, 0
    s_cbranch_scc1 L_m_nowd_51
    v_min_u32 v144, 11, v1
    v_lshrrev_b32 v145, 2, v144
    v_mul_u32_u24 v145, 28672, v145
    v_lshl_add_u32 v144, v144, 4, v145
    ds_read_b128 v[148:151], v144 offset:14336
    v_bfe_u32 v64, v1, 3, 2
    v_and_b32 v65, 3, v1
    v_lshl_add_u32 v64, v64, 2, v65
    s_lshl_b32 s12, s8, 4
    v_add_u32 v64, s12, v64
    v_bfe_u32 v65, v1, 2, 1
    v_or_b32 v66, v64, v65
    v_cmp_eq_u32 vcc, 0, v66
    v_mov_b32 v66, 224
    s_nop 0
    v_cndmask_b32 v64, v64, v66, vcc
    v_cvt_f32_u32 v64, v64
    v_cvt_f32_u32 v65, v65
    v_mul_f32 v129, 0x3b124925, v64
    v_mul_f32 v128, 0x3e800000, v65
    v_lshrrev_b32 v66, 5, v1
    s_mul_i32 s12, s10, 7168
    s_add_u32 s12, s12, 86208
    v_add_u32 v131, s12, v2
    v_mul_f32 v130, 0x41000000, v129
    v_lshlrev_b32 v67, 31, v66
    v_xor_b32 v130, v130, v67
    s_mul_i32 s12, s10, 7
    v_cvt_f32_u32 v67, s12
    v_fmac_f32 v128, v130, v67
    v_cvt_f32_u32 v66, v66
    v_mul_f32 v67, 0xc0e00000, v66
    v_fmac_f32 v128, v129, v67
    s_cmp_eq_u32 s10, 0
    s_cselect_b32 s12, 0.5, 0
    v_mul_f32 v66, s12, v66
    v_mul_f32 v89, v64, v66
    v_fmamk_f32 v65, v129, 0x3f800000, v128
    v_fmamk_f32 v66, v129, 0x40000000, v128
    v_fmamk_f32 v67, v129, 0x40400000, v128
    v_cos_f32 v64, v128
    v_cos_f32 v65, v65
    v_cos_f32 v66, v66
    v_cos_f32 v67, v67
    v_cvt_pk_bf16_f32 v80, v64, v65
    v_cvt_pk_bf16_f32 v81, v66, v67
    v_fmamk_f32 v68, v129, 0x40800000, v128
    v_fmamk_f32 v69, v129, 0x40a00000, v128
    v_fmamk_f32 v70, v129, 0x40c00000, v128
    v_fmamk_f32 v71, v129, 0x40e00000, v128
    v_add_f32 v89, v71, v89
    v_cos_f32 v89, v89
    v_cos_f32 v68, v68
    v_cos_f32 v69, v69
    v_cos_f32 v70, v70
    v_cos_f32 v71, v71
    v_cvt_pk_bf16_f32 v82, v68, v69
    v_cvt_pk_bf16_f32 v83, v70, v89
    ds_write_b128 v131, v[80:83] offset:0
    v_add_f32 v88, v130, v128
    v_cos_f32 v90, v130
    v_fmamk_f32 v73, v129, 0x3f800000, v88
    v_fmamk_f32 v74, v129, 0x40000000, v88
    v_fmamk_f32 v75, v129, 0x40400000, v88
    v_cos_f32 v72, v88
    v_cos_f32 v73, v73
    v_cos_f32 v74, v74
    v_cos_f32 v75, v75
    v_cvt_pk_bf16_f32 v84, v72, v73
    v_cvt_pk_bf16_f32 v85, v74, v75
    v_fmamk_f32 v76, v129, 0x40800000, v88
    v_fmamk_f32 v77, v129, 0x40a00000, v88
    v_fmamk_f32 v78, v129, 0x40c00000, v88
    v_fmamk_f32 v79, v129, 0x40e00000, v88
    v_cos_f32 v76, v76
    v_cos_f32 v77, v77
    v_cos_f32 v78, v78
    v_cos_f32 v79, v79
    v_add_f32 v90, v90, v90
    v_cvt_pk_bf16_f32 v86, v76, v77
    v_cvt_pk_bf16_f32 v87, v78, v79
    ds_write_b128 v131, v[84:87] offset:1024
    v_pk_fma_f32 v[64:65], v[72:73], v[90:91], v[64:65] op_sel_hi:[1,0,1] neg_lo:[0,0,1] neg_hi:[0,0,1]
    v_pk_fma_f32 v[66:67], v[74:75], v[90:91], v[66:67] op_sel_hi:[1,0,1] neg_lo:[0,0,1] neg_hi:[0,0,1]
    v_pk_fma_f32 v[68:69], v[76:77], v[90:91], v[68:69] op_sel_hi:[1,0,1] neg_lo:[0,0,1] neg_hi:[0,0,1]
    v_pk_fma_f32 v[70:71], v[78:79], v[90:91], v[70:71] op_sel_hi:[1,0,1] neg_lo:[0,0,1] neg_hi:[0,0,1]
    v_cvt_pk_bf16_f32 v80, v64, v65
    v_cvt_pk_bf16_f32 v81, v66, v67
    v_cvt_pk_bf16_f32 v82, v68, v69
    v_cvt_pk_bf16_f32 v83, v70, v71
    ds_write_b128 v131, v[80:83] offset:2048
    v_pk_fma_f32 v[72:73], v[64:65], v[90:91], v[72:73] op_sel_hi:[1,0,1] neg_lo:[0,0,1] neg_hi:[0,0,1]
    v_pk_fma_f32 v[74:75], v[66:67], v[90:91], v[74:75] op_sel_hi:[1,0,1] neg_lo:[0,0,1] neg_hi:[0,0,1]
    v_pk_fma_f32 v[76:77], v[68:69], v[90:91], v[76:77] op_sel_hi:[1,0,1] neg_lo:[0,0,1] neg_hi:[0,0,1]
    v_pk_fma_f32 v[78:79], v[70:71], v[90:91], v[78:79] op_sel_hi:[1,0,1] neg_lo:[0,0,1] neg_hi:[0,0,1]
    v_cvt_pk_bf16_f32 v84, v72, v73
    v_cvt_pk_bf16_f32 v85, v74, v75
    v_cvt_pk_bf16_f32 v86, v76, v77
    v_cvt_pk_bf16_f32 v87, v78, v79
    ds_write_b128 v131, v[84:87] offset:3072
    v_pk_fma_f32 v[64:65], v[72:73], v[90:91], v[64:65] op_sel_hi:[1,0,1] neg_lo:[0,0,1] neg_hi:[0,0,1]
    v_pk_fma_f32 v[66:67], v[74:75], v[90:91], v[66:67] op_sel_hi:[1,0,1] neg_lo:[0,0,1] neg_hi:[0,0,1]
    v_pk_fma_f32 v[68:69], v[76:77], v[90:91], v[68:69] op_sel_hi:[1,0,1] neg_lo:[0,0,1] neg_hi:[0,0,1]
    v_pk_fma_f32 v[70:71], v[78:79], v[90:91], v[70:71] op_sel_hi:[1,0,1] neg_lo:[0,0,1] neg_hi:[0,0,1]
    v_cvt_pk_bf16_f32 v80, v64, v65
    v_cvt_pk_bf16_f32 v81, v66, v67
    v_cvt_pk_bf16_f32 v82, v68, v69
    v_cvt_pk_bf16_f32 v83, v70, v71
    ds_write_b128 v131, v[80:83] offset:4096
    v_pk_fma_f32 v[72:73], v[64:65], v[90:91], v[72:73] op_sel_hi:[1,0,1] neg_lo:[0,0,1] neg_hi:[0,0,1]
    v_pk_fma_f32 v[74:75], v[66:67], v[90:91], v[74:75] op_sel_hi:[1,0,1] neg_lo:[0,0,1] neg_hi:[0,0,1]
    v_pk_fma_f32 v[76:77], v[68:69], v[90:91], v[76:77] op_sel_hi:[1,0,1] neg_lo:[0,0,1] neg_hi:[0,0,1]
    v_pk_fma_f32 v[78:79], v[70:71], v[90:91], v[78:79] op_sel_hi:[1,0,1] neg_lo:[0,0,1] neg_hi:[0,0,1]
    v_cvt_pk_bf16_f32 v84, v72, v73
    v_cvt_pk_bf16_f32 v85, v74, v75
    v_cvt_pk_bf16_f32 v86, v76, v77
    v_cvt_pk_bf16_f32 v87, v78, v79
    ds_write_b128 v131, v[84:87] offset:5120
    v_pk_fma_f32 v[64:65], v[72:73], v[90:91], v[64:65] op_sel_hi:[1,0,1] neg_lo:[0,0,1] neg_hi:[0,0,1]
    v_pk_fma_f32 v[66:67], v[74:75], v[90:91], v[66:67] op_sel_hi:[1,0,1] neg_lo:[0,0,1] neg_hi:[0,0,1]
    v_pk_fma_f32 v[68:69], v[76:77], v[90:91], v[68:69] op_sel_hi:[1,0,1] neg_lo:[0,0,1] neg_hi:[0,0,1]
    v_pk_fma_f32 v[70:71], v[78:79], v[90:91], v[70:71] op_sel_hi:[1,0,1] neg_lo:[0,0,1] neg_hi:[0,0,1]
    v_cvt_pk_bf16_f32 v80, v64, v65
    v_cvt_pk_bf16_f32 v81, v66, v67
    v_cvt_pk_bf16_f32 v82, v68, v69
    v_cvt_pk_bf16_f32 v83, v70, v71
    ds_write_b128 v131, v[80:83] offset:6144
    s_waitcnt lgkmcnt(7)
    ds_write_b128 v144, v[148:151] offset:28672
L_m_nowd_51:
    s_waitcnt vmcnt(1)
    v_max3_u32 v24, v16, v17, v18
    s_waitcnt vmcnt(0)
    v_max3_u32 v25, v19, v20, v21
    v_max3_u32 v24, v24, v22, v23
    v_max_u32 v24, v24, v25
    v_cmp_eq_u32 vcc, -1, v24
    s_cbranch_vccz L_m_rb_53
    s_mov_b32 s34, 0
L_m_rs_52:
    s_sleep 4
    buffer_load_dwordx4 v[16:19], v2, s[20:23], s14 offen offset:0 sc1
    buffer_load_dwordx4 v[20:23], v2, s[20:23], s14 offen offset:1024 sc1
    s_waitcnt vmcnt(1)
    v_max3_u32 v24, v16, v17, v18
    s_waitcnt vmcnt(0)
    v_max3_u32 v25, v19, v20, v21
    v_max3_u32 v24, v24, v22, v23
    v_max_u32 v24, v24, v25
    v_cmp_eq_u32 vcc, -1, v24
    s_cbranch_vccz L_m_rb_53
    s_add_u32 s34, s34, 1
    s_cmp_lt_u32 s34, 65536
    s_cbranch_scc1 L_m_rs_52
L_m_rb_53:
    ds_write_b128 v3, v[16:19] offset:0
    ds_write_b128 v3, v[20:23] offset:1024
    s_waitcnt lgkmcnt(0)
    s_barrier
    ds_read_b64_tr_b16 a[0:1], v6 offset:0
    ds_read_b64_tr_b16 a[2:3], v6 offset:512
    ds_read_b64_tr_b16 a[16:17], v8 offset:0
    ds_read_b64_tr_b16 a[18:19], v8 offset:512
    ds_read_b64_tr_b16 a[4:5], v6 offset:2048
    ds_read_b64_tr_b16 a[6:7], v6 offset:2560
    ds_read_b64_tr_b16 a[20:21], v8 offset:2048
    ds_read_b64_tr_b16 a[22:23], v8 offset:2560
    ds_read_b64_tr_b16 a[8:9], v6 offset:4096
    ds_read_b64_tr_b16 a[10:11], v6 offset:4608
    ds_read_b64_tr_b16 a[24:25], v8 offset:4096
    ds_read_b64_tr_b16 a[26:27], v8 offset:4608
    ds_read_b64_tr_b16 a[12:13], v6 offset:6144
    ds_read_b64_tr_b16 a[14:15], v6 offset:6656
    ds_read_b64_tr_b16 a[28:29], v8 offset:6144
    ds_read_b64_tr_b16 a[30:31], v8 offset:6656
    s_add_u32 s20, s20, 3020800
    s_addc_u32 s21, s21, 0
    s_cmp_eq_u32 s8, 0
    s_cselect_b32 s32, -1, 0
    s_mov_b32 s33, 0
    s_waitcnt lgkmcnt(14)
    v_mfma_f32_32x32x16_bf16 v[128:143], a[0:3], v[32:35], 0
    s_waitcnt lgkmcnt(12)
    v_mfma_f32_32x32x16_bf16 v[144:159], a[16:19], v[48:51], 0
    s_waitcnt lgkmcnt(10)
    v_mfma_f32_32x32x16_bf16 v[128:143], a[4:7], v[36:39], v[128:143]
    s_waitcnt lgkmcnt(8)
    v_mfma_f32_32x32x16_bf16 v[144:159], a[20:23], v[52:55], v[144:159]
    s_waitcnt lgkmcnt(6)
    v_mfma_f32_32x32x16_bf16 v[128:143], a[8:11], v[40:43], v[128:143]
    s_waitcnt lgkmcnt(4)
    v_mfma_f32_32x32x16_bf16 v[144:159], a[24:27], v[56:59], v[144:159]
    s_waitcnt lgkmcnt(2)
    v_mfma_f32_32x32x16_bf16 v[128:143], a[12:15], v[44:47], v[128:143]
    s_waitcnt lgkmcnt(0)
    v_mfma_f32_32x32x16_bf16 v[144:159], a[28:31], v[60:63], v[144:159]
    s_nop 11
    v_pk_fma_f32 v[128:129], v[152:153], s[16:17], v[128:129] op_sel_hi:[1,0,1]
    v_pk_fma_f32 v[144:145], v[136:137], s[16:17], v[144:145] op_sel_hi:[1,0,1] neg_lo:[0,0,1] neg_hi:[0,0,1]
    v_pk_fma_f32 v[130:131], v[154:155], s[16:17], v[130:131] op_sel_hi:[1,0,1]
    v_pk_fma_f32 v[146:147], v[138:139], s[16:17], v[146:147] op_sel_hi:[1,0,1] neg_lo:[0,0,1] neg_hi:[0,0,1]
    v_pk_fma_f32 v[132:133], v[156:157], s[16:17], v[132:133] op_sel_hi:[1,0,1]
    v_pk_fma_f32 v[148:149], v[140:141], s[16:17], v[148:149] op_sel_hi:[1,0,1] neg_lo:[0,0,1] neg_hi:[0,0,1]
    v_pk_fma_f32 v[134:135], v[158:159], s[16:17], v[134:135] op_sel_hi:[1,0,1]
    v_pk_fma_f32 v[150:151], v[142:143], s[16:17], v[150:151] op_sel_hi:[1,0,1] neg_lo:[0,0,1] neg_hi:[0,0,1]
    v_pk_add_f32 v[160:161], v[160:161], v[128:129]
    v_pk_add_f32 v[174:175], v[174:175], v[128:129] op_sel:[0,1] op_sel_hi:[1,0]
    v_pk_add_f32 v[162:163], v[162:163], v[130:131]
    v_pk_add_f32 v[172:173], v[172:173], v[130:131] op_sel:[0,1] op_sel_hi:[1,0]
    v_pk_add_f32 v[164:165], v[164:165], v[132:133]
    v_pk_add_f32 v[170:171], v[170:171], v[132:133] op_sel:[0,1] op_sel_hi:[1,0]
    v_pk_add_f32 v[166:167], v[166:167], v[134:135]
    v_pk_add_f32 v[168:169], v[168:169], v[134:135] op_sel:[0,1] op_sel_hi:[1,0]
    v_pk_add_f32 v[160:161], v[160:161], v[144:145] neg_lo:[0,1] neg_hi:[0,1]
    v_pk_add_f32 v[162:163], v[162:163], v[146:147] neg_lo:[0,1] neg_hi:[0,1]
    v_pk_add_f32 v[164:165], v[164:165], v[148:149] neg_lo:[0,1] neg_hi:[0,1]
    v_pk_add_f32 v[166:167], v[166:167], v[150:151] neg_lo:[0,1] neg_hi:[0,1]
    v_cndmask_b32 v160, v160, v192, s[32:33]
    v_pk_add_f32 v[174:175], v[174:175], v[144:145] op_sel:[0,1] op_sel_hi:[1,0]
    v_pk_add_f32 v[172:173], v[172:173], v[146:147] op_sel:[0,1] op_sel_hi:[1,0]
    v_pk_add_f32 v[170:171], v[170:171], v[148:149] op_sel:[0,1] op_sel_hi:[1,0]
    v_pk_add_f32 v[168:169], v[168:169], v[150:151] op_sel:[0,1] op_sel_hi:[1,0]
    v_cvt_pk_bf16_f32 v240, v160, v161
    v_cvt_pk_bf16_f32 v241, v162, v163
    v_cvt_pk_bf16_f32 v242, v164, v165
    v_cvt_pk_bf16_f32 v243, v166, v167
    v_cvt_pk_bf16_f32 v244, v168, v169
    v_cvt_pk_bf16_f32 v245, v170, v171
    v_cvt_pk_bf16_f32 v246, v172, v173
    v_cvt_pk_bf16_f32 v247, v174, v175
    s_cmp_eq_u32 s40, 0
    s_cbranch_scc1 L_m_final_54
    s_cmp_eq_u32 s50, 0
    s_cbranch_scc0 L_m_md_55
    buffer_store_dwordx4 v[240:243], v9, s[4:7], s44 offen offset:0
    buffer_store_dwordx4 v[244:247], v9, s[4:7], s44 offen offset:512
    v_pk_add_f32 v[192:193], v[160:161], v[162:163]
    v_pk_mul_f32 v[194:195], v[160:161], v[160:161]
    v_pk_fma_f32 v[194:195], v[162:163], v[162:163], v[194:195]
    v_pk_add_f32 v[192:193], v[192:193], v[164:165]
    v_pk_fma_f32 v[194:195], v[164:165], v[164:165], v[194:195]
    v_pk_add_f32 v[192:193], v[192:193], v[166:167]
    v_pk_fma_f32 v[194:195], v[166:167], v[166:167], v[194:195]
    v_pk_add_f32 v[192:193], v[192:193], v[168:169]
    v_pk_fma_f32 v[194:195], v[168:169], v[168:169], v[194:195]
    v_pk_add_f32 v[192:193], v[192:193], v[170:171]
    v_pk_fma_f32 v[194:195], v[170:171], v[170:171], v[194:195]
    v_pk_add_f32 v[192:193], v[192:193], v[172:173]
    v_pk_fma_f32 v[194:195], v[172:173], v[172:173], v[194:195]
    v_pk_add_f32 v[192:193], v[192:193], v[174:175]
    v_pk_fma_f32 v[194:195], v[174:175], v[174:175], v[194:195]
    v_add_f32 v192, v192, v193
    v_add_f32 v194, v194, v195
    s_nop 1
    v_permlane32_swap_b32 v192, v194
    v_add_f32 v192, v192, v194
    buffer_store_dword v192, v7, s[4:7], s53 offen
L_m_md_56:
    v_accvgpr_write_b32 a140, v160
    v_accvgpr_write_b32 a141, v161
    v_accvgpr_write_b32 a142, v162
    v_accvgpr_write_b32 a143, v163
    v_accvgpr_write_b32 a144, v164
    v_accvgpr_write_b32 a145, v165
    v_accvgpr_write_b32 a146, v166
    v_accvgpr_write_b32 a147, v167
    v_accvgpr_write_b32 a148, v168
    v_accvgpr_write_b32 a149, v169
    v_accvgpr_write_b32 a150, v170
    v_accvgpr_write_b32 a151, v171
    v_accvgpr_write_b32 a152, v172
    v_accvgpr_write_b32 a153, v173
    v_accvgpr_write_b32 a154, v174
    v_accvgpr_write_b32 a155, v175
L_m_join_57:
    s_load_dwordx2 s[24:25], s[0:1], 72
    s_mov_b32 s40, 0
    v_mul_u32_u24 v6, 27712, v4
    v_add_u32 v15, v15, v6
    v_lshlrev_b32 v6, 10, v4
    v_sub_u32 v14, 512, v6
    v_mov_b32 v3, v15
    v_xor_b32 v13, 0x10000, v13
    s_waitcnt lgkmcnt(0)
    ds_read_b64_tr_b16 a[0:1], v3 offset:0
    ds_read_b64_tr_b16 a[2:3], v3 offset:256
    ds_read_b64_tr_b16 a[4:5], v3 offset:28736
    ds_read_b64_tr_b16 a[6:7], v3 offset:28992
    v_add_u32 v3, v3, v14
    ds_read_b64_tr_b16 a[8:9], v3 offset:0
    ds_read_b64_tr_b16 a[10:11], v3 offset:256
    ds_read_b64_tr_b16 a[12:13], v3 offset:28736
    ds_read_b64_tr_b16 a[14:15], v3 offset:28992
    v_add_u32 v3, v3, v14
    ds_read_b64_tr_b16 a[16:17], v3 offset:0
    ds_read_b64_tr_b16 a[18:19], v3 offset:256
    ds_read_b64_tr_b16 a[20:21], v3 offset:28736
    ds_read_b64_tr_b16 a[22:23], v3 offset:28992
    v_add_u32 v3, v3, v14
    s_add_u32 s35, s13, 0
    buffer_load_dwordx4 v[16:19], v2, s[4:7], s35 offen offset:0 sc1
    buffer_load_dwordx4 v[20:23], v2, s[4:7], s35 offen offset:1024 sc1
    buffer_load_dwordx4 v[24:27], v2, s[4:7], s35 offen offset:2048 sc1
    buffer_load_dwordx4 v[28:31], v2, s[4:7], s35 offen offset:3072 sc1
    s_add_u32 s35, s13, 4096
    buffer_load_dwordx4 v[32:35], v2, s[4:7], s35 offen offset:0 sc1
    buffer_load_dwordx4 v[36:39], v2, s[4:7], s35 offen offset:1024 sc1
    buffer_load_dwordx4 v[40:43], v2, s[4:7], s35 offen offset:2048 sc1
    buffer_load_dwordx4 v[44:47], v2, s[4:7], s35 offen offset:3072 sc1
    v_mul_u32_u24 v7, 224, v5
    v_lshl_add_u32 v7, v4, 5, v7
    s_mul_i32 s12, s10, 7168
    v_add_u32 v7, s12, v7
    v_add_u32 v7, 114880, v7
    v_lshrrev_b32 v6, 2, v1
    v_mul_u32_u24 v6, 224, v6
    v_and_b32 v9, 3, v1
    v_lshl_add_u32 v6, v9, 3, v6
    v_mov_b32 v9, v6
    s_and_b32 s12, s10, 1
    s_lshl_b32 s12, s12, 5
    s_add_u32 s12, s12, 115008
    v_add_u32 v6, s12, v6
    s_and_b32 s12, s10, 2
    s_lshl_b32 s12, s12, 5
    s_add_u32 s12, s12, 114880
    v_add_u32 v9, s12, v9
    v_add_u32 v11, 86208, v2
    s_waitcnt vmcnt(4)
    v_max3_u32 v8, v31, v23, v27
    v_max_u32 v8, v8, v19
    v_cmp_eq_u32 vcc, -1, v8
    s_cbranch_vccz L_m_rb_59
    s_mov_b32 s34, 0
L_m_rs_58:
    s_add_u32 s12, s13, 0
    buffer_load_dwordx4 v[16:19], v2, s[4:7], s12 offen offset:0 sc1
    buffer_load_dwordx4 v[20:23], v2, s[4:7], s12 offen offset:1024 sc1
    buffer_load_dwordx4 v[24:27], v2, s[4:7], s12 offen offset:2048 sc1
    buffer_load_dwordx4 v[28:31], v2, s[4:7], s12 offen offset:3072 sc1
    s_waitcnt vmcnt(0)
    v_max3_u32 v8, v31, v23, v27
    v_max_u32 v8, v8, v19
    v_cmp_eq_u32 vcc, -1, v8
    s_cbranch_vccz L_m_ro_60
    s_add_u32 s34, s34, 1
    s_cmp_lt_u32 s34, 262144
    s_cbranch_scc1 L_m_rs_58
L_m_ro_60:
    s_add_u32 s12, s13, 4096
    buffer_load_dwordx4 v[32:35], v2, s[4:7], s12 offen offset:0 sc1
    buffer_load_dwordx4 v[36:39], v2, s[4:7], s12 offen offset:1024 sc1
    buffer_load_dwordx4 v[40:43], v2, s[4:7], s12 offen offset:2048 sc1
    buffer_load_dwordx4 v[44:47], v2, s[4:7], s12 offen offset:3072 sc1
L_m_rb_59:
    s_waitcnt lgkmcnt(8)
    v_mfma_f32_32x32x16_bf16 v[128:143], a[0:3], v[16:19], 0
    ds_read_b64_tr_b16 a[24:25], v3 offset:0
    ds_read_b64_tr_b16 a[26:27], v3 offset:256
    s_add_u32 s35, s13, 8192
    buffer_load_dwordx4 v[48:51], v2, s[4:7], s35 offen offset:0 sc1
    v_mfma_f32_32x32x16_bf16 v[144:159], a[4:7], v[16:19], 0
    ds_read_b64_tr_b16 a[28:29], v3 offset:28736
    ds_read_b64_tr_b16 a[30:31], v3 offset:28992
    v_add_u32 v3, v3, v14
    buffer_load_dwordx4 v[52:55], v2, s[4:7], s35 offen offset:1024 sc1
    s_waitcnt lgkmcnt(8)
    v_mfma_f32_32x32x16_bf16 v[128:143], a[8:11], v[20:23], v[128:143]
    ds_read_b64_tr_b16 a[0:1], v3 offset:0
    ds_read_b64_tr_b16 a[2:3], v3 offset:256
    buffer_load_dwordx4 v[56:59], v2, s[4:7], s35 offen offset:2048 sc1
    v_mfma_f32_32x32x16_bf16 v[144:159], a[12:15], v[20:23], v[144:159]
    ds_read_b64_tr_b16 a[4:5], v3 offset:28736
    ds_read_b64_tr_b16 a[6:7], v3 offset:28992
    v_add_u32 v3, v3, v14
    buffer_load_dwordx4 v[60:63], v2, s[4:7], s35 offen offset:3072 sc1
    s_waitcnt lgkmcnt(8)
    v_mfma_f32_32x32x16_bf16 v[128:143], a[16:19], v[24:27], v[128:143]
    ds_read_b64_tr_b16 a[8:9], v3 offset:0
    ds_read_b64_tr_b16 a[10:11], v3 offset:256
    s_add_u32 s35, s13, 12288
    buffer_load_dwordx4 v[64:67], v2, s[4:7], s35 offen offset:0 sc1
    v_mfma_f32_32x32x16_bf16 v[144:159], a[20:23], v[24:27], v[144:159]
    ds_read_b64_tr_b16 a[12:13], v3 offset:28736
    ds_read_b64_tr_b16 a[14:15], v3 offset:28992
    v_add_u32 v3, v3, v14
    buffer_load_dwordx4 v[68:71], v2, s[4:7], s35 offen offset:1024 sc1
    s_waitcnt lgkmcnt(8)
    v_mfma_f32_32x32x16_bf16 v[128:143], a[24:27], v[28:31], v[128:143]
    ds_read_b64_tr_b16 a[16:17], v3 offset:0
    ds_read_b64_tr_b16 a[18:19], v3 offset:256
    s_waitcnt vmcnt(6)
    v_max3_u32 v8, v47, v39, v43
    v_max_u32 v8, v8, v35
    v_cmp_eq_u32 vcc, -1, v8
    v_mfma_f32_32x32x16_bf16 v[144:159], a[28:31], v[28:31], v[144:159]
    ds_read_b64_tr_b16 a[20:21], v3 offset:28736
    ds_read_b64_tr_b16 a[22:23], v3 offset:28992
    v_add_u32 v3, v3, v14
    s_cbranch_vccnz L_m_rs_61
L_m_rb_62:
    buffer_load_dwordx4 v[72:75], v2, s[4:7], s35 offen offset:2048 sc1
    s_waitcnt lgkmcnt(8)
    v_mfma_f32_32x32x16_bf16 v[128:143], a[0:3], v[32:35], v[128:143]
    ds_read_b64_tr_b16 a[24:25], v3 offset:0
    ds_read_b64_tr_b16 a[26:27], v3 offset:256
    buffer_load_dwordx4 v[76:79], v2, s[4:7], s35 offen offset:3072 sc1
    v_mfma_f32_32x32x16_bf16 v[144:159], a[4:7], v[32:35], v[144:159]
    ds_read_b64_tr_b16 a[28:29], v3 offset:28736
    ds_read_b64_tr_b16 a[30:31], v3 offset:28992
    v_add_u32 v3, v3, v14
    s_waitcnt lgkmcnt(8)
    v_mfma_f32_32x32x16_bf16 v[128:143], a[8:11], v[36:39], v[128:143]
    ds_read_b64_tr_b16 a[0:1], v3 offset:0
    ds_read_b64_tr_b16 a[2:3], v3 offset:256
    s_add_u32 s35, s13, 16384
    buffer_load_dwordx4 v[80:83], v2, s[4:7], s35 offen offset:0 sc1
    v_mfma_f32_32x32x16_bf16 v[144:159], a[12:15], v[36:39], v[144:159]
    ds_read_b64_tr_b16 a[4:5], v3 offset:28736
    ds_read_b64_tr_b16 a[6:7], v3 offset:28992
    v_add_u32 v3, v3, v14
    s_waitcnt lgkmcnt(8)
    v_mfma_f32_32x32x16_bf16 v[128:143], a[16:19], v[40:43], v[128:143]
    ds_read_b64_tr_b16 a[8:9], v3 offset:0
    ds_read_b64_tr_b16 a[10:11], v3 offset:256
    buffer_load_dwordx4 v[84:87], v2, s[4:7], s35 offen offset:1024 sc1
    v_mfma_f32_32x32x16_bf16 v[144:159], a[20:23], v[40:43], v[144:159]
    ds_read_b64_tr_b16 a[12:13], v3 offset:28736
    ds_read_b64_tr_b16 a[14:15], v3 offset:28992
    v_add_u32 v3, v3, v14
    s_waitcnt lgkmcnt(8)
    v_mfma_f32_32x32x16_bf16 v[128:143], a[24:27], v[44:47], v[128:143]
    ds_read_b64_tr_b16 a[16:17], v3 offset:0
    ds_read_b64_tr_b16 a[18:19], v3 offset:256
    s_waitcnt vmcnt(6)
    v_max3_u32 v8, v63, v55, v59
    v_max_u32 v8, v8, v51
    v_cmp_eq_u32 vcc, -1, v8
    v_mfma_f32_32x32x16_bf16 v[144:159], a[28:31], v[44:47], v[144:159]
    ds_read_b64_tr_b16 a[20:21], v3 offset:28736
    ds_read_b64_tr_b16 a[22:23], v3 offset:28992
    v_add_u32 v3, v3, v14
    s_cbranch_vccnz L_m_rs_63
L_m_rb_64:
    buffer_load_dwordx4 v[88:91], v2, s[4:7], s35 offen offset:2048 sc1
    s_waitcnt lgkmcnt(8)
    v_mfma_f32_32x32x16_bf16 v[128:143], a[0:3], v[48:51], v[128:143]
    ds_read_b64_tr_b16 a[24:25], v3 offset:0
    ds_read_b64_tr_b16 a[26:27], v3 offset:256
    buffer_load_dwordx4 v[92:95], v2, s[4:7], s35 offen offset:3072 sc1
    v_mfma_f32_32x32x16_bf16 v[144:159], a[4:7], v[48:51], v[144:159]
    ds_read_b64_tr_b16 a[28:29], v3 offset:28736
    ds_read_b64_tr_b16 a[30:31], v3 offset:28992
    v_add_u32 v3, v3, v14
    s_waitcnt lgkmcnt(8)
    v_mfma_f32_32x32x16_bf16 v[128:143], a[8:11], v[52:55], v[128:143]
    ds_read_b64_tr_b16 a[0:1], v3 offset:0
    ds_read_b64_tr_b16 a[2:3], v3 offset:256
    s_add_u32 s35, s13, 20480
    buffer_load_dwordx4 v[96:99], v2, s[4:7], s35 offen offset:0 sc1
    v_mfma_f32_32x32x16_bf16 v[144:159], a[12:15], v[52:55], v[144:159]
    ds_read_b64_tr_b16 a[4:5], v3 offset:28736
    ds_read_b64_tr_b16 a[6:7], v3 offset:28992
    v_add_u32 v3, v3, v14
    s_waitcnt lgkmcnt(8)
    v_mfma_f32_32x32x16_bf16 v[128:143], a[16:19], v[56:59], v[128:143]
    ds_read_b64_tr_b16 a[8:9], v3 offset:0
    ds_read_b64_tr_b16 a[10:11], v3 offset:256
    buffer_load_dwordx4 v[100:103], v2, s[4:7], s35 offen offset:1024 sc1
    v_mfma_f32_32x32x16_bf16 v[144:159], a[20:23], v[56:59], v[144:159]
    ds_read_b64_tr_b16 a[12:13], v3 offset:28736
    ds_read_b64_tr_b16 a[14:15], v3 offset:28992
    v_add_u32 v3, v3, v14
    s_waitcnt lgkmcnt(8)
    v_mfma_f32_32x32x16_bf16 v[128:143], a[24:27], v[60:63], v[128:143]
    ds_read_b64_tr_b16 a[16:17], v3 offset:0
    ds_read_b64_tr_b16 a[18:19], v3 offset:256
    s_waitcnt vmcnt(6)
    v_max3_u32 v8, v79, v71, v75
    v_max_u32 v8, v8, v67
    v_cmp_eq_u32 vcc, -1, v8
    v_mfma_f32_32x32x16_bf16 v[144:159], a[28:31], v[60:63], v[144:159]
    ds_read_b64_tr_b16 a[20:21], v3 offset:28736
    ds_read_b64_tr_b16 a[22:23], v3 offset:28992
    v_add_u32 v3, v3, v14
    s_cbranch_vccnz L_m_rs_65
L_m_rb_66:
    buffer_load_dwordx4 v[104:107], v2, s[4:7], s35 offen offset:2048 sc1
    s_waitcnt lgkmcnt(8)
    v_mfma_f32_32x32x16_bf16 v[128:143], a[0:3], v[64:67], v[128:143]
    ds_read_b64_tr_b16 a[24:25], v3 offset:0
    ds_read_b64_tr_b16 a[26:27], v3 offset:256
    buffer_load_dwordx4 v[108:111], v2, s[4:7], s35 offen offset:3072 sc1
    v_mfma_f32_32x32x16_bf16 v[144:159], a[4:7], v[64:67], v[144:159]
    ds_read_b64_tr_b16 a[28:29], v3 offset:28736
    ds_read_b64_tr_b16 a[30:31], v3 offset:28992
    v_add_u32 v3, v3, v14
    s_waitcnt lgkmcnt(8)
    v_mfma_f32_32x32x16_bf16 v[128:143], a[8:11], v[68:71], v[128:143]
    ds_read_b64_tr_b16 a[0:1], v3 offset:0
    ds_read_b64_tr_b16 a[2:3], v3 offset:256
    s_add_u32 s35, s13, 24576
    buffer_load_dwordx4 v[112:115], v2, s[4:7], s35 offen offset:0 sc1
    v_mfma_f32_32x32x16_bf16 v[144:159], a[12:15], v[68:71], v[144:159]
    ds_read_b64_tr_b16 a[4:5], v3 offset:28736
    ds_read_b64_tr_b16 a[6:7], v3 offset:28992
    v_add_u32 v3, v3, v14
    s_waitcnt lgkmcnt(8)
    v_mfma_f32_32x32x16_bf16 v[128:143], a[16:19], v[72:75], v[128:143]
    ds_read_b64_tr_b16 a[8:9], v3 offset:0
    ds_read_b64_tr_b16 a[10:11], v3 offset:256
    buffer_load_dwordx4 v[116:119], v2, s[4:7], s35 offen offset:1024 sc1
    v_mfma_f32_32x32x16_bf16 v[144:159], a[20:23], v[72:75], v[144:159]
    ds_read_b64_tr_b16 a[12:13], v3 offset:28736
    ds_read_b64_tr_b16 a[14:15], v3 offset:28992
    v_add_u32 v3, v3, v14
    s_waitcnt lgkmcnt(8)
    v_mfma_f32_32x32x16_bf16 v[128:143], a[24:27], v[76:79], v[128:143]
    ds_read_b64_tr_b16 a[16:17], v3 offset:0
    ds_read_b64_tr_b16 a[18:19], v3 offset:256
    s_waitcnt vmcnt(6)
    v_max3_u32 v8, v95, v87, v91
    v_max_u32 v8, v8, v83
    v_cmp_eq_u32 vcc, -1, v8
    v_mfma_f32_32x32x16_bf16 v[144:159], a[28:31], v[76:79], v[144:159]
    ds_read_b64_tr_b16 a[20:21], v3 offset:28736
    ds_read_b64_tr_b16 a[22:23], v3 offset:28992
    v_add_u32 v3, v3, v14
    s_cbranch_vccnz L_m_rs_67
L_m_rb_68:
    buffer_load_dwordx4 v[120:123], v2, s[4:7], s35 offen offset:2048 sc1
    s_waitcnt lgkmcnt(8)
    v_mfma_f32_32x32x16_bf16 v[128:143], a[0:3], v[80:83], v[128:143]
    ds_read_b64_tr_b16 a[24:25], v3 offset:0
    ds_read_b64_tr_b16 a[26:27], v3 offset:256
    buffer_load_dwordx4 v[124:127], v2, s[4:7], s35 offen offset:3072 sc1
    v_mfma_f32_32x32x16_bf16 v[144:159], a[4:7], v[80:83], v[144:159]
    ds_read_b64_tr_b16 a[28:29], v3 offset:28736
    ds_read_b64_tr_b16 a[30:31], v3 offset:28992
    v_add_u32 v3, v3, v14
    s_waitcnt lgkmcnt(8)
    v_mfma_f32_32x32x16_bf16 v[128:143], a[8:11], v[84:87], v[128:143]
    ds_read_b64_tr_b16 a[0:1], v3 offset:0
    ds_read_b64_tr_b16 a[2:3], v3 offset:256
    buffer_load_dwordx4 v[200:203], v2, s[4:7], s54 offen offset:0 sc1
    v_mfma_f32_32x32x16_bf16 v[144:159], a[12:15], v[84:87], v[144:159]
    ds_read_b64_tr_b16 a[4:5], v3 offset:28736
    ds_read_b64_tr_b16 a[6:7], v3 offset:28992
    v_add_u32 v3, v3, v14
    s_waitcnt lgkmcnt(8)
    v_mfma_f32_32x32x16_bf16 v[128:143], a[16:19], v[88:91], v[128:143]
    ds_read_b64_tr_b16 a[8:9], v3 offset:0
    ds_read_b64_tr_b16 a[10:11], v3 offset:256
    buffer_load_dwordx4 v[204:207], v2, s[4:7], s54 offen offset:1024 sc1
    v_mfma_f32_32x32x16_bf16 v[144:159], a[20:23], v[88:91], v[144:159]
    ds_read_b64_tr_b16 a[12:13], v3 offset:28736
    ds_read_b64_tr_b16 a[14:15], v3 offset:28992
    v_add_u32 v3, v3, v14
    s_waitcnt lgkmcnt(8)
    v_mfma_f32_32x32x16_bf16 v[128:143], a[24:27], v[92:95], v[128:143]
    ds_read_b64_tr_b16 a[16:17], v3 offset:0
    ds_read_b64_tr_b16 a[18:19], v3 offset:256
    s_waitcnt vmcnt(6)
    v_max3_u32 v8, v111, v103, v107
    v_max_u32 v8, v8, v99
    v_cmp_eq_u32 vcc, -1, v8
    v_mfma_f32_32x32x16_bf16 v[144:159], a[28:31], v[92:95], v[144:159]
    ds_read_b64_tr_b16 a[20:21], v3 offset:28736
    ds_read_b64_tr_b16 a[22:23], v3 offset:28992
    v_add_u32 v3, v3, v14
    s_cbranch_vccnz L_m_rs_69
L_m_rb_70:
    buffer_load_dwordx4 v[208:211], v2, s[4:7], s54 offen offset:2048 sc1
    s_waitcnt lgkmcnt(8)
    v_mfma_f32_32x32x16_bf16 v[128:143], a[0:3], v[96:99], v[128:143]
    ds_read_b64_tr_b16 a[24:25], v3 offset:0
    ds_read_b64_tr_b16 a[26:27], v3 offset:256
    buffer_load_dwordx4 v[212:215], v2, s[4:7], s54 offen offset:3072 sc1
    s_barrier
    v_mfma_f32_32x32x16_bf16 v[144:159], a[4:7], v[96:99], v[144:159]
    ds_read_b64_tr_b16 a[28:29], v3 offset:28736
    ds_read_b64_tr_b16 a[30:31], v3 offset:28992
    v_add_u32 v3, v3, v14
    s_waitcnt lgkmcnt(8)
    v_mfma_f32_32x32x16_bf16 v[128:143], a[8:11], v[100:103], v[128:143]
    ds_read_b64_tr_b16 a[0:1], v3 offset:0
    ds_read_b64_tr_b16 a[2:3], v3 offset:256
    v_mfma_f32_32x32x16_bf16 v[144:159], a[12:15], v[100:103], v[144:159]
    ds_read_b64_tr_b16 a[4:5], v3 offset:28736
    ds_read_b64_tr_b16 a[6:7], v3 offset:28992
    v_add_u32 v3, v3, v14
    s_waitcnt lgkmcnt(8)
    v_mfma_f32_32x32x16_bf16 v[128:143], a[16:19], v[104:107], v[128:143]
    ds_read_b64_tr_b16 a[8:9], v3 offset:0
    ds_read_b64_tr_b16 a[10:11], v3 offset:256
    v_mfma_f32_32x32x16_bf16 v[144:159], a[20:23], v[104:107], v[144:159]
    ds_read_b64_tr_b16 a[12:13], v3 offset:28736
    ds_read_b64_tr_b16 a[14:15], v3 offset:28992
    v_add_u32 v3, v3, v14
    s_waitcnt lgkmcnt(8)
    v_mfma_f32_32x32x16_bf16 v[128:143], a[24:27], v[108:111], v[128:143]
    ds_read_b64_tr_b16 a[16:17], v3 offset:0
    ds_read_b64_tr_b16 a[18:19], v3 offset:256
    s_waitcnt vmcnt(4)
    v_max3_u32 v8, v127, v119, v123
    v_max_u32 v8, v8, v115
    v_cmp_eq_u32 vcc, -1, v8
    v_mfma_f32_32x32x16_bf16 v[144:159], a[28:31], v[108:111], v[144:159]
    ds_read_b64_tr_b16 a[20:21], v3 offset:28736
    ds_read_b64_tr_b16 a[22:23], v3 offset:28992
    v_add_u32 v3, v3, v14
    s_cbranch_vccnz L_m_rs_71
L_m_rb_72:
    s_waitcnt lgkmcnt(8)
    v_mfma_f32_32x32x16_bf16 v[128:143], a[0:3], v[112:115], v[128:143]
    ds_read_b64_tr_b16 a[24:25], v3 offset:0
    ds_read_b64_tr_b16 a[26:27], v3 offset:256
    s_waitcnt vmcnt(2)
    v_add_f32 v200, v200, v204
    v_add_f32 v201, v201, v205
    v_add_f32 v202, v202, v206
    v_mfma_f32_32x32x16_bf16 v[144:159], a[4:7], v[112:115], v[144:159]
    ds_read_b64_tr_b16 a[28:29], v3 offset:28736
    ds_read_b64_tr_b16 a[30:31], v3 offset:28992
    v_add_f32 v203, v203, v207
    s_waitcnt vmcnt(0)
    v_add_f32 v208, v208, v212
    s_waitcnt lgkmcnt(8)
    v_mfma_f32_32x32x16_bf16 v[128:143], a[8:11], v[116:119], v[128:143]
    v_add_f32 v209, v209, v213
    v_add_f32 v210, v210, v214
    v_add_f32 v211, v211, v215
    v_add_f32 v200, v200, v208
    v_add_f32 v201, v201, v209
    v_mfma_f32_32x32x16_bf16 v[144:159], a[12:15], v[116:119], v[144:159]
    v_add_f32 v202, v202, v210
    v_add_f32 v203, v203, v211
    v_permlane32_swap_b32 v200, v201
    s_nop 0
    v_permlane32_swap_b32 v202, v203
    v_add_f32 v200, v200, v201
    s_waitcnt lgkmcnt(4)
    v_mfma_f32_32x32x16_bf16 v[128:143], a[16:19], v[120:123], v[128:143]
    v_add_f32 v202, v202, v203
    s_nop 1
    v_permlane16_swap_b32 v200, v202
    v_add_f32 v200, v200, v202
    v_cmp_u_f32 vcc, v200, v200
    s_cbranch_vccz L_m_rb_74
    s_mov_b32 s34, 0
L_m_rs_73:
    s_sleep 1
    buffer_load_dwordx4 v[200:203], v2, s[4:7], s54 offen offset:0 sc1
    buffer_load_dwordx4 v[204:207], v2, s[4:7], s54 offen offset:1024 sc1
    buffer_load_dwordx4 v[208:211], v2, s[4:7], s54 offen offset:2048 sc1
    buffer_load_dwordx4 v[212:215], v2, s[4:7], s54 offen offset:3072 sc1
    s_waitcnt vmcnt(2)
    v_add_f32 v200, v200, v204
    v_add_f32 v201, v201, v205
    v_add_f32 v202, v202, v206
    v_add_f32 v203, v203, v207
    s_waitcnt vmcnt(0)
    v_add_f32 v208, v208, v212
    v_add_f32 v209, v209, v213
    v_add_f32 v210, v210, v214
    v_add_f32 v211, v211, v215
    v_add_f32 v200, v200, v208
    v_add_f32 v201, v201, v209
    v_add_f32 v202, v202, v210
    v_add_f32 v203, v203, v211
    v_permlane32_swap_b32 v200, v201
    s_nop 0
    v_permlane32_swap_b32 v202, v203
    v_add_f32 v200, v200, v201
    v_add_f32 v202, v202, v203
    s_nop 1
    v_permlane16_swap_b32 v200, v202
    v_add_f32 v200, v200, v202
    v_cmp_u_f32 vcc, v200, v200
    s_cbranch_vccz L_m_rb_74
    s_add_u32 s34, s34, 1
    s_cmp_lt_u32 s34, 262144
    s_cbranch_scc1 L_m_rs_73
L_m_rb_74:
    v_mfma_f32_32x32x16_bf16 v[144:159], a[20:23], v[120:123], v[144:159]
    v_mov_b32 v201, v200
    v_mov_b32 v202, 0x3727c5ac
    s_nop 0
    v_permlane32_swap_b32 v200, v201
    v_mul_f32 v200, 0xbb124925, v200
    v_mul_f32 v204, 0.5, v200
    s_waitcnt lgkmcnt(0)
    v_mfma_f32_32x32x16_bf16 v[128:143], a[24:27], v[124:127], v[128:143]
    v_cvt_pk_bf16_f32 v203, v204, v204
    v_accvgpr_write_b32 a120, v203
    v_lshlrev_b32 v203, 16, v203
    v_sub_f32 v204, v204, v203
    v_cvt_pk_bf16_f32 v204, v204, 0
    v_accvgpr_write_b32 a121, v204
    s_nop 1
    v_mfma_f32_32x32x16_bf16 v[128:143], a[156:159], a[120:123], v[128:143]
    v_mfma_f32_32x32x16_bf16 v[144:159], a[28:31], v[124:127], v[144:159]
    v_fmac_f32 v202, 0x3b124925, v201
    v_fma_f32 v202, -v200, v200, v202
    v_rsq_f32 v12, v202
    s_nop 0
    v_mul_f32 v10, 0x3fb8aa3b, v12
    v_mul_f32 v12, v202, v12
    v_mfma_f32_32x32x16_bf16 v[144:159], a[160:163], a[120:123], v[144:159]
    s_nop 3
    v_cvt_pk_bf16_f32 v192, v128, v129
    v_cvt_pk_bf16_f32 v193, v130, v131
    v_cvt_pk_bf16_f32 v194, v132, v133
    v_cvt_pk_bf16_f32 v195, v134, v135
    v_cvt_pk_bf16_f32 v196, v136, v137
    v_cvt_pk_bf16_f32 v197, v138, v139
    v_cvt_pk_bf16_f32 v198, v140, v141
    v_cvt_pk_bf16_f32 v199, v142, v143
    v_mfma_f32_32x32x16_bf16 v[128:143], a[124:127], v[192:195], 0
    s_nop 0
    v_mfma_f32_32x32x16_bf16 v[128:143], a[128:131], v[196:199], v[128:143]
    s_mov_b32 exec_lo, 0
    v_mov_b32 v147, v12
    v_mov_b32 v155, v12
    s_mov_b32 exec_lo, -1
    v_cvt_pk_bf16_f32 v232, v144, v145
    v_cvt_pk_bf16_f32 v233, v146, v147
    v_cvt_pk_bf16_f32 v234, v148, v149
    v_cvt_pk_bf16_f32 v235, v150, v151
    v_cvt_pk_bf16_f32 v236, v152, v153
    v_cvt_pk_bf16_f32 v237, v154, v155
    v_cvt_pk_bf16_f32 v238, v156, v157
    v_cvt_pk_bf16_f32 v239, v158, v159
    ds_write_b128 v7, v[232:235] offset:128
    ds_write_b128 v7, v[236:239] offset:144
    v_max3_f32 v192, v128, v129, v130
    v_min3_f32 v194, v128, v129, v130
    v_max3_f32 v192, v192, v131, v132
    v_min3_f32 v194, v194, v131, v132
    v_max3_f32 v192, v192, v133, v134
    v_min3_f32 v194, v194, v133, v134
    v_max3_f32 v192, v192, v135, v136
    v_min3_f32 v194, v194, v135, v136
    v_max3_f32 v192, v192, v137, v138
    v_min3_f32 v194, v194, v137, v138
    v_max3_f32 v192, v192, v139, v140
    v_min3_f32 v194, v194, v139, v140
    v_max_f32 v192, v192, v141
    v_min_f32 v194, v194, v141
    v_mov_b32 v196, v192
    v_mov_b32 v197, v194
    s_nop 0
    v_permlane32_swap_b32 v196, v192
    v_permlane32_swap_b32 v197, v194
    v_max_f32 v192, v192, v196
    v_min_f32 v194, v194, v197
    v_mul_f32 v192, v192, v10
    v_mul_f32 v194, v194, v10
    v_pk_fma_f32 v[198:199], v[128:129], v[10:11], v[192:193] op_sel_hi:[1,0,0] neg_lo:[0,0,1] neg_hi:[0,0,1]
    v_pk_fma_f32 v[200:201], v[130:131], v[10:11], v[192:193] op_sel_hi:[1,0,0] neg_lo:[0,0,1] neg_hi:[0,0,1]
    v_pk_fma_f32 v[202:203], v[132:133], v[10:11], v[192:193] op_sel_hi:[1,0,0] neg_lo:[0,0,1] neg_hi:[0,0,1]
    v_pk_fma_f32 v[204:205], v[134:135], v[10:11], v[192:193] op_sel_hi:[1,0,0] neg_lo:[0,0,1] neg_hi:[0,0,1]
    v_pk_fma_f32 v[206:207], v[136:137], v[10:11], v[192:193] op_sel_hi:[1,0,0] neg_lo:[0,0,1] neg_hi:[0,0,1]
    v_pk_fma_f32 v[208:209], v[138:139], v[10:11], v[192:193] op_sel_hi:[1,0,0] neg_lo:[0,0,1] neg_hi:[0,0,1]
    v_pk_fma_f32 v[210:211], v[140:141], v[10:11], v[192:193] op_sel_hi:[1,0,0] neg_lo:[0,0,1] neg_hi:[0,0,1]
    v_pk_fma_f32 v[212:213], v[128:129], v[10:11], v[194:195] op_sel_hi:[1,0,0] neg_lo:[1,0,0] neg_hi:[1,0,0]
    v_pk_fma_f32 v[214:215], v[130:131], v[10:11], v[194:195] op_sel_hi:[1,0,0] neg_lo:[1,0,0] neg_hi:[1,0,0]
    v_pk_fma_f32 v[216:217], v[132:133], v[10:11], v[194:195] op_sel_hi:[1,0,0] neg_lo:[1,0,0] neg_hi:[1,0,0]
    v_pk_fma_f32 v[218:219], v[134:135], v[10:11], v[194:195] op_sel_hi:[1,0,0] neg_lo:[1,0,0] neg_hi:[1,0,0]
    v_pk_fma_f32 v[220:221], v[136:137], v[10:11], v[194:195] op_sel_hi:[1,0,0] neg_lo:[1,0,0] neg_hi:[1,0,0]
    v_pk_fma_f32 v[222:223], v[138:139], v[10:11], v[194:195] op_sel_hi:[1,0,0] neg_lo:[1,0,0] neg_hi:[1,0,0]
    v_pk_fma_f32 v[224:225], v[140:141], v[10:11], v[194:195] op_sel_hi:[1,0,0] neg_lo:[1,0,0] neg_hi:[1,0,0]
    v_exp_f32 v198, v198
    v_exp_f32 v199, v199
    v_exp_f32 v200, v200
    v_exp_f32 v201, v201
    v_exp_f32 v202, v202
    v_exp_f32 v203, v203
    v_exp_f32 v204, v204
    v_exp_f32 v205, v205
    v_exp_f32 v206, v206
    v_exp_f32 v207, v207
    v_exp_f32 v208, v208
    v_exp_f32 v209, v209
    v_exp_f32 v210, v210
    v_exp_f32 v211, v211
    v_exp_f32 v212, v212
    v_exp_f32 v213, v213
    v_exp_f32 v214, v214
    v_exp_f32 v215, v215
    v_exp_f32 v216, v216
    v_exp_f32 v217, v217
    v_exp_f32 v218, v218
    v_exp_f32 v219, v219
    v_exp_f32 v220, v220
    v_exp_f32 v221, v221
    v_exp_f32 v222, v222
    v_exp_f32 v223, v223
    v_exp_f32 v224, v224
    v_exp_f32 v225, v225
    v_pk_add_f32 v[192:193], v[198:199], v[200:201]
    v_pk_add_f32 v[194:195], v[212:213], v[214:215]
    v_pk_add_f32 v[192:193], v[192:193], v[202:203]
    v_pk_add_f32 v[194:195], v[194:195], v[216:217]
    v_pk_add_f32 v[192:193], v[192:193], v[204:205]
    v_pk_add_f32 v[194:195], v[194:195], v[218:219]
    v_pk_add_f32 v[192:193], v[192:193], v[206:207]
    v_pk_add_f32 v[194:195], v[194:195], v[220:221]
    v_pk_add_f32 v[192:193], v[192:193], v[208:209]
    v_pk_add_f32 v[194:195], v[194:195], v[222:223]
    v_pk_add_f32 v[192:193], v[192:193], v[210:211]
    v_pk_add_f32 v[194:195], v[194:195], v[224:225]
    v_add_f32 v192, v192, v193
    v_add_f32 v194, v194, v195
    v_mov_b32 v196, v192
    v_mov_b32 v197, v194
    s_nop 0
    v_permlane32_swap_b32 v196, v192
    v_permlane32_swap_b32 v197, v194
    v_add_f32 v192, v192, v196
    v_add_f32 v194, v194, v197
    v_mul_f32 v192, v192, v12
    v_mul_f32 v194, v194, v12
    v_rcp_f32 v192, v192
    v_rcp_f32 v194, v194
    v_pk_mul_f32 v[198:199], v[198:199], v[192:193] op_sel_hi:[1,0]
    v_pk_mul_f32 v[200:201], v[200:201], v[192:193] op_sel_hi:[1,0]
    v_pk_mul_f32 v[202:203], v[202:203], v[192:193] op_sel_hi:[1,0]
    v_pk_mul_f32 v[204:205], v[204:205], v[192:193] op_sel_hi:[1,0]
    v_pk_mul_f32 v[206:207], v[206:207], v[192:193] op_sel_hi:[1,0]
    v_pk_mul_f32 v[208:209], v[208:209], v[192:193] op_sel_hi:[1,0]
    v_pk_mul_f32 v[210:211], v[210:211], v[192:193] op_sel_hi:[1,0]
    v_cvt_pk_bf16_f32 v240, v198, v199
    v_cvt_pk_bf16_f32 v241, v200, v201
    v_cvt_pk_bf16_f32 v242, v202, v203
    v_cvt_pk_bf16_f32 v243, v204, 0
    v_cvt_pk_bf16_f32 v244, v205, v206
    v_cvt_pk_bf16_f32 v245, v207, v208
    v_cvt_pk_bf16_f32 v246, v209, v210
    v_cvt_pk_bf16_f32 v247, v211, 0
    ds_write_b128 v7, v[240:243]
    ds_write_b128 v7, v[244:247] offset:16
    v_pk_mul_f32 v[212:213], v[212:213], v[194:195] op_sel_hi:[1,0]
    v_pk_mul_f32 v[214:215], v[214:215], v[194:195] op_sel_hi:[1,0]
    v_pk_mul_f32 v[216:217], v[216:217], v[194:195] op_sel_hi:[1,0]
    v_pk_mul_f32 v[218:219], v[218:219], v[194:195] op_sel_hi:[1,0]
    v_pk_mul_f32 v[220:221], v[220:221], v[194:195] op_sel_hi:[1,0]
    v_pk_mul_f32 v[222:223], v[222:223], v[194:195] op_sel_hi:[1,0]
    v_pk_mul_f32 v[224:225], v[224:225], v[194:195] op_sel_hi:[1,0]
    v_cvt_pk_bf16_f32 v248, v212, v213
    v_cvt_pk_bf16_f32 v249, v214, v215
    v_cvt_pk_bf16_f32 v250, v216, v217
    v_cvt_pk_bf16_f32 v251, v218, 0
    ds_write_b128 v7, v[248:251] offset:64
    v_cvt_pk_bf16_f32 v252, v219, v220
    v_cvt_pk_bf16_f32 v253, v221, v222
    v_cvt_pk_bf16_f32 v254, v223, v224
    v_cvt_pk_bf16_f32 v255, v225, 0
    ds_write_b128 v7, v[252:255] offset:80
    s_waitcnt lgkmcnt(0)
    s_branch L_m_common_2
L_m_spare_27:
    s_cmp_eq_u32 s40, 0
    s_cbranch_scc1 L_m_wbl_75
    s_and_b32 s12, s8, 1
    s_mul_i32 s12, s12, 14336
    s_mul_i32 s44, s11, 28672
    s_add_u32 s44, s44, 2625536
    s_add_u32 s12, s12, s44
    v_min_u32 v6, 55, v1
    v_lshlrev_b32 v6, 7, v6
    buffer_load_dword v0, v6, s[4:7], s12 offen sc1
    s_add_u32 s12, s12, 7168
    buffer_load_dword v0, v6, s[4:7], s12 offen sc1
    v_lshlrev_b32 v6, 7, v5
    buffer_load_dword v0, v6, s[4:7], s54 offen sc1
    s_add_u32 s20, s20, 3020800
    s_addc_u32 s21, s21, 0
    v_lshrrev_b32 v3, 3, v1
    v_mul_u32_u24 v3, 115072, v3
    v_and_b32 v6, 0x70, v2
    v_add_u32 v3, v3, v6
    v_add_u32 v6, 920576, v3
    s_and_b32 s12, s8, 1
    s_mul_i32 s12, s12, 57344
    s_lshl_b32 s14, s45, 7
    s_add_u32 s12, s12, s14
    v_mov_b32 v200, -1
    v_mov_b32 v201, -1
    v_mov_b32 v202, -1
    v_mov_b32 v203, -1
    buffer_store_dwordx4 v[200:203], v3, s[20:23], s12 offen sc1
    buffer_store_dwordx4 v[200:203], v6, s[20:23], s12 offen sc1
    s_add_u32 s12, s12, 8192
    buffer_store_dwordx4 v[200:203], v3, s[20:23], s12 offen sc1
    buffer_store_dwordx4 v[200:203], v6, s[20:23], s12 offen sc1
    s_add_u32 s12, s12, 8192
    buffer_store_dwordx4 v[200:203], v3, s[20:23], s12 offen sc1
    buffer_store_dwordx4 v[200:203], v6, s[20:23], s12 offen sc1
    s_add_u32 s12, s12, 8192
    buffer_store_dwordx4 v[200:203], v3, s[20:23], s12 offen sc1
    buffer_store_dwordx4 v[200:203], v6, s[20:23], s12 offen sc1
    s_add_u32 s12, s12, 8192
    buffer_store_dwordx4 v[200:203], v3, s[20:23], s12 offen sc1
    buffer_store_dwordx4 v[200:203], v6, s[20:23], s12 offen sc1
    s_add_u32 s12, s12, 8192
    buffer_store_dwordx4 v[200:203], v3, s[20:23], s12 offen sc1
    buffer_store_dwordx4 v[200:203], v6, s[20:23], s12 offen sc1
    s_add_u32 s12, s12, 8192
    buffer_store_dwordx4 v[200:203], v3, s[20:23], s12 offen sc1
    buffer_store_dwordx4 v[200:203], v6, s[20:23], s12 offen sc1
    s_add_u32 s12, s12, 8192
    v_min_u32 v144, 11, v1
    v_lshrrev_b32 v145, 2, v144
    v_mul_u32_u24 v145, 28672, v145
    v_lshl_add_u32 v144, v144, 4, v145
    ds_read_b128 v[148:151], v144 offset:14336
    s_waitcnt lgkmcnt(0)
    ds_write_b128 v144, v[148:151] offset:28672
    v_lshrrev_b32 v6, 2, v1
    v_lshlrev_b32 v6, 11, v6
    v_and_b32 v7, 0x30, v2
    v_add_u32 v6, v6, v7
    s_mov_b32 s34, 0
L_m_sp_76:
    buffer_load_dword v7, v6, s[4:7], s13 offen offset:12 sc1
    s_waitcnt vmcnt(0)
    v_xor_b32 v7, v13, v7
    v_cmp_lt_u32 vcc, s17, v7
    s_cbranch_vccz L_m_sg_77
    s_sleep 8
    s_add_u32 s34, s34, 1
    s_cmp_lt_u32 s34, 1048576
    s_cbranch_scc1 L_m_sp_76
L_m_sg_77:
    v_mov_b32 v6, 0
    v_lshlrev_b32 v7, 2, v1
    s_waitcnt vmcnt(0)
    s_cmp_eq_u32 s50, 0
    s_cbranch_scc0 L_m_md_78
    buffer_store_dword v6, v7, s[4:7], s53 offen
L_m_md_79:
    v_lshrrev_b32 v6, 3, v1
    v_and_b32 v7, 7, v1
    v_lshlrev_b32 v3, 13, v7
    v_lshlrev_b32 v7, 7, v7
    v_lshl_add_u32 v6, v6, 16, v7
    s_and_b32 s12, s8, 1
    s_mul_i32 s12, s12, 7
    s_sub_u32 s12, 14, s12
    s_lshl_b32 s14, s12, 16
    s_sub_u32 s14, s41, s14
    buffer_load_dword v0, v6, s[20:23], s14 offen sc1
    s_lshl_b32 s14, s12, 13
    s_sub_u32 s14, s46, s14
    buffer_load_dword v0, v3, s[20:23], s14 offen sc1
    s_mov_b32 s13, s44
    v_min_u32 v6, 13, v1
    v_lshlrev_b32 v6, 8, v6
    s_mov_b32 s34, 0
L_m_sp_80:
    buffer_load_dword v7, v6, s[4:7], s54 offen sc1
    s_waitcnt vmcnt(0)
    v_cmp_eq_u32 vcc, -1, v7
    s_cbranch_vccz L_m_sg_81
    s_sleep 2
    s_add_u32 s34, s34, 1
    s_cmp_lt_u32 s34, 1048576
    s_cbranch_scc1 L_m_sp_80
L_m_sg_81:
    s_waitcnt lgkmcnt(0)
    s_branch L_m_join_57
L_m_final_54:
    v_permlane32_swap_b32 v240, v244
    v_permlane32_swap_b32 v241, v245
    v_permlane32_swap_b32 v242, v246
    v_permlane32_swap_b32 v243, v247
    s_cmp_lg_u32 s8, 0
    s_cbranch_scc1 L_m_gen_82
    s_mov_b32 exec_lo, 0
    v_mul_u32_u24 v8, 57344, v5
    buffer_store_short_d16_hi v243, v8, s[24:27], s56 offen offset:448
    v_and_b32 v6, 1, v1
    v_lshlrev_b32 v6, 1, v6
    v_sub_u32 v10, v10, v6
    v_sub_u32 v11, v11, v6
    v_alignbit_b32 v243, v243, v242, 16
    v_alignbit_b32 v242, v242, v241, 16
    v_alignbit_b32 v241, v241, v240, 16
    v_alignbit_b32 v240, v240, v247, 16
    s_mov_b32 exec_lo, -1
    s_or_b32 s12, s2, s10
    s_cmp_eq_u32 s12, 0
    s_cselect_b32 s12, 0, 2147418112
    v_mov_b32 v200, s48
    v_mov_b32 v201, s49
    v_mov_b32 v202, s12
    buffer_store_dwordx2 v[200:201], v202, s[4:7], 0 offen
L_m_gen_82:
    s_mov_b32 vcc_lo, 0x55555555
    s_mov_b32 vcc_hi, 0xaaaaaaaa
    v_cndmask_b32_dpp v192, v244, v240, vcc quad_perm:[1,0,3,2] row_mask:0xf bank_mask:0xf
    v_cndmask_b32_dpp v193, v245, v241, vcc quad_perm:[1,0,3,2] row_mask:0xf bank_mask:0xf
    v_cndmask_b32_dpp v194, v246, v242, vcc quad_perm:[1,0,3,2] row_mask:0xf bank_mask:0xf
    v_cndmask_b32_dpp v195, v247, v243, vcc quad_perm:[1,0,3,2] row_mask:0xf bank_mask:0xf
    s_not_b64 vcc, vcc
    buffer_store_dwordx4 v[192:195], v10, s[24:27], s56 offen
    v_cndmask_b32_dpp v196, v240, v244, vcc quad_perm:[1,0,3,2] row_mask:0xf bank_mask:0xf
    v_cndmask_b32_dpp v197, v241, v245, vcc quad_perm:[1,0,3,2] row_mask:0xf bank_mask:0xf
    v_cndmask_b32_dpp v198, v242, v246, vcc quad_perm:[1,0,3,2] row_mask:0xf bank_mask:0xf
    v_cndmask_b32_dpp v199, v243, v247, vcc quad_perm:[1,0,3,2] row_mask:0xf bank_mask:0xf
    buffer_store_dwordx4 v[196:199], v11, s[24:27], s56 offen
L_m_end_1:
    s_endpgm
L_m_rs_3:
    s_mov_b32 s34, 0
L_m_rl_83:
    s_sleep 4
    s_mov_b32 s33, m0
    s_add_u32 m0, s15, 0
    s_add_u32 s44, s14, 0
    buffer_load_dwordx4 v2, s[4:7], s44 offen sc1 lds
    s_add_u32 m0, s15, 28736
    s_add_u32 s44, s14, 28672
    buffer_load_dwordx4 v2, s[4:7], s44 offen sc1 lds
    s_waitcnt vmcnt(0)
    s_mov_b32 m0, s33
    ds_read_b32 v200, v9 offset:12
    ds_read_b32 v201, v9 offset:28748
    s_waitcnt lgkmcnt(0)
    v_xor_b32 v201, v8, v201
    v_bitop3_b32 v200, v8, v200, v201 bitop3:0xbe
    v_cmp_lt_u32 vcc, 0xffff, v200
    s_nop 0
    s_cmp_eq_u64 vcc, 0
    s_cbranch_scc1 L_m_rb_4
    s_add_u32 s34, s34, 1
    s_cmp_lt_u32 s34, 262144
    s_cbranch_scc1 L_m_rl_83
    s_branch L_m_rb_4
L_m_rs_5:
    s_mov_b32 s34, 0
L_m_rl_84:
    s_sleep 4
    s_mov_b32 s33, m0
    s_add_u32 m0, s15, 4096
    s_add_u32 s44, s14, 4096
    buffer_load_dwordx4 v2, s[4:7], s44 offen sc1 lds
    s_add_u32 m0, s15, 32832
    s_add_u32 s44, s14, 32768
    buffer_load_dwordx4 v2, s[4:7], s44 offen sc1 lds
    s_add_u32 m0, s15, 8192
    s_add_u32 s44, s14, 8192
    buffer_load_dwordx4 v2, s[4:7], s44 offen sc1 lds
    s_add_u32 m0, s15, 36928
    s_add_u32 s44, s14, 36864
    buffer_load_dwordx4 v2, s[4:7], s44 offen sc1 lds
    s_waitcnt vmcnt(0)
    s_mov_b32 m0, s33
    ds_read_b32 v200, v9 offset:4108
    ds_read_b32 v201, v9 offset:32844
    ds_read_b32 v202, v9 offset:8204
    ds_read_b32 v203, v9 offset:36940
    s_waitcnt lgkmcnt(0)
    v_xor_b32 v203, v8, v203
    v_bitop3_b32 v202, v8, v202, v203 bitop3:0xbe
    v_bitop3_b32 v201, v8, v201, v202 bitop3:0xbe
    v_bitop3_b32 v200, v8, v200, v201 bitop3:0xbe
    v_cmp_lt_u32 vcc, 0xffff, v200
    s_nop 0
    s_cmp_eq_u64 vcc, 0
    s_cbranch_scc1 L_m_rb_6
    s_add_u32 s34, s34, 1
    s_cmp_lt_u32 s34, 262144
    s_cbranch_scc1 L_m_rl_84
    s_branch L_m_rb_6
L_m_rs_7:
    s_mov_b32 s34, 0
L_m_rl_85:
    s_sleep 4
    s_mov_b32 s33, m0
    s_add_u32 m0, s15, 12288
    s_add_u32 s44, s14, 12288
    buffer_load_dwordx4 v2, s[4:7], s44 offen sc1 lds
    s_add_u32 m0, s15, 41024
    s_add_u32 s44, s14, 40960
    buffer_load_dwordx4 v2, s[4:7], s44 offen sc1 lds
    s_add_u32 m0, s15, 16384
    s_add_u32 s44, s14, 16384
    buffer_load_dwordx4 v2, s[4:7], s44 offen sc1 lds
    s_add_u32 m0, s15, 45120
    s_add_u32 s44, s14, 45056
    buffer_load_dwordx4 v2, s[4:7], s44 offen sc1 lds
    s_add_u32 m0, s15, 73856
    s_add_u32 s44, s36, 0
    buffer_load_dwordx4 v2, s[4:7], s44 offen sc1 lds
    s_add_u32 m0, s15, 77952
    s_add_u32 s44, s36, 4096
    buffer_load_dwordx4 v2, s[4:7], s44 offen sc1 lds
    s_add_u32 m0, s15, 82048
    s_add_u32 s44, s36, 8192
    buffer_load_dwordx4 v2, s[4:7], s44 offen sc1 lds
    s_waitcnt vmcnt(0)
    s_mov_b32 m0, s33
    ds_read_b32 v200, v9 offset:12300
    ds_read_b32 v201, v9 offset:41036
    ds_read_b32 v202, v9 offset:16396
    ds_read_b32 v203, v9 offset:45132
    ds_read_b32 v204, v6 offset:12
    ds_read_b32 v205, v6 offset:4108
    ds_read_b32 v206, v6 offset:8204
    s_waitcnt lgkmcnt(0)
    v_xor_b32 v206, v8, v206
    v_bitop3_b32 v205, v8, v205, v206 bitop3:0xbe
    v_bitop3_b32 v204, v8, v204, v205 bitop3:0xbe
    v_bitop3_b32 v203, v8, v203, v204 bitop3:0xbe
    v_bitop3_b32 v202, v8, v202, v203 bitop3:0xbe
    v_bitop3_b32 v201, v8, v201, v202 bitop3:0xbe
    v_bitop3_b32 v200, v8, v200, v201 bitop3:0xbe
    v_cmp_lt_u32 vcc, 0xffff, v200
    s_nop 0
    s_cmp_eq_u64 vcc, 0
    s_cbranch_scc1 L_m_rb_8
    s_add_u32 s34, s34, 1
    s_cmp_lt_u32 s34, 262144
    s_cbranch_scc1 L_m_rl_85
    s_branch L_m_rb_8
L_m_rs_9:
    s_mov_b32 s34, 0
L_m_rl_86:
    s_sleep 4
    s_mov_b32 s33, m0
    s_add_u32 m0, s15, 20480
    s_add_u32 s44, s14, 20480
    buffer_load_dwordx4 v2, s[4:7], s44 offen sc1 lds
    s_add_u32 m0, s15, 49216
    s_add_u32 s44, s14, 49152
    buffer_load_dwordx4 v2, s[4:7], s44 offen sc1 lds
    s_add_u32 m0, s15, 24576
    s_add_u32 s44, s14, 24576
    buffer_load_dwordx4 v2, s[4:7], s44 offen sc1 lds
    s_add_u32 m0, s15, 53312
    s_add_u32 s44, s14, 53248
    buffer_load_dwordx4 v2, s[4:7], s44 offen sc1 lds
    s_waitcnt vmcnt(0)
    s_mov_b32 m0, s33
    ds_read_b32 v200, v9 offset:20492
    ds_read_b32 v201, v9 offset:49228
    ds_read_b32 v202, v9 offset:24588
    ds_read_b32 v203, v9 offset:53324
    s_waitcnt lgkmcnt(0)
    v_xor_b32 v203, v8, v203
    v_bitop3_b32 v202, v8, v202, v203 bitop3:0xbe
    v_bitop3_b32 v201, v8, v201, v202 bitop3:0xbe
    v_bitop3_b32 v200, v8, v200, v201 bitop3:0xbe
    v_cmp_lt_u32 vcc, 0xffff, v200
    s_nop 0
    s_cmp_eq_u64 vcc, 0
    s_cbranch_scc1 L_m_rb_10
    s_add_u32 s34, s34, 1
    s_cmp_lt_u32 s34, 262144
    s_cbranch_scc1 L_m_rl_86
    s_branch L_m_rb_10
L_m_s0_11:
    s_mov_b32 s34, 0
L_m_s0a_87:
    buffer_load_dwordx4 v[192:195], v252, s[4:7], s55 offen sc1
    s_waitcnt vmcnt(0)
    v_cmp_ne_u32 vcc, s42, v193
    v_cmp_ne_u32 s[32:33], s43, v195
    s_nop 0
    s_or_b64 vcc, vcc, s[32:33]
    s_cbranch_scc0 L_m_s0r_12
    s_add_u32 s34, s34, 1
    s_cmp_lt_u32 s34, 24
    s_cbranch_scc1 L_m_s0a_87
    s_lshl_b32 s13, s11, 11
    s_add_u32 s13, s13, 7114752
    s_lshl_b32 s12, s8, 7
    s_add_u32 s12, s12, s13
    v_lshrrev_b32 v198, 1, v5
    v_and_b32 v199, 16, v252
    v_lshl_add_u32 v198, v198, 7, v199
    s_mov_b32 exec_lo, 0x10001
    s_mov_b32 exec_hi, 0x10001
    buffer_store_dwordx2 v[240:241], v253, s[4:7], s12 offen sc1
    s_mov_b64 exec, -1
    s_mov_b32 s34, 0
L_m_s0b_88:
    buffer_load_dwordx4 v[192:195], v252, s[4:7], s55 offen sc1
    s_waitcnt vmcnt(0)
    v_cmp_ne_u32 vcc, s42, v193
    v_cmp_ne_u32 s[32:33], s43, v195
    s_nop 0
    s_or_b64 vcc, vcc, s[32:33]
    s_cbranch_scc0 L_m_s0r_12
    buffer_load_dwordx4 v[192:195], v198, s[4:7], s13 offen sc1
    s_waitcnt vmcnt(0)
    v_mov_b32 v199, v193
    v_and_b32 v193, 0xfffffff0, v193
    v_cmp_ne_u32 vcc, s48, v193
    v_cmp_ne_u32 s[32:33], s43, v195
    s_nop 0
    s_or_b64 vcc, vcc, s[32:33]
    s_cbranch_scc0 L_m_s0c_89
    s_sleep 8
    s_add_u32 s34, s34, 1
    s_cmp_lt_u32 s34, 0x80000
    s_cbranch_scc1 L_m_s0b_88
L_m_s0c_89:
    v_cmp_ne_u32 vcc, s42, v199
    s_nop 0
    s_cmp_lg_u64 vcc, 0
    s_cselect_b32 s50, 1, 0
    s_branch L_m_s0r_12
L_m_md_13:
    buffer_store_dword v204, v205, s[4:7], s55 offen sc1
    s_branch L_m_md_14
L_m_md_17:
    buffer_store_dwordx4 v[220:223], v6, s[4:7], s12 offen sc1
    buffer_store_dwordx4 v[220:223], v6, s[4:7], s12 offen offset:1024 sc1
    buffer_store_dword v220, v205, s[4:7], s53 offen sc1
    s_branch L_m_md_18
L_m_rs_19:
    s_mov_b32 s34, 0
L_m_rl_90:
    s_sleep 4
    s_mov_b32 s33, m0
    s_add_u32 m0, s15, 57472
    s_add_u32 s44, s14, 57344
    buffer_load_dwordx4 v2, s[4:7], s44 offen sc1 lds
    s_add_u32 m0, s15, 61568
    s_add_u32 s44, s14, 61440
    buffer_load_dwordx4 v2, s[4:7], s44 offen sc1 lds
    s_add_u32 m0, s15, 65664
    s_add_u32 s44, s14, 65536
    buffer_load_dwordx4 v2, s[4:7], s44 offen sc1 lds
    s_add_u32 m0, s15, 69760
    s_add_u32 s44, s14, 69632
    buffer_load_dwordx4 v2, s[4:7], s44 offen sc1 lds
    s_add_u32 m0, s15, 73856
    s_add_u32 s44, s14, 73728
    buffer_load_dwordx4 v2, s[4:7], s44 offen sc1 lds
    s_add_u32 m0, s15, 77952
    s_add_u32 s44, s14, 77824
    buffer_load_dwordx4 v2, s[4:7], s44 offen sc1 lds
    s_add_u32 m0, s15, 82048
    s_add_u32 s44, s14, 81920
    buffer_load_dwordx4 v2, s[4:7], s44 offen sc1 lds
    s_waitcnt vmcnt(0)
    s_mov_b32 m0, s33
    ds_read_b32 v168, v9 offset:12
    ds_read_b32 v169, v9 offset:4108
    ds_read_b32 v170, v9 offset:8204
    ds_read_b32 v171, v9 offset:12300
    ds_read_b32 v172, v9 offset:16396
    ds_read_b32 v173, v9 offset:20492
    ds_read_b32 v174, v9 offset:24588
    s_waitcnt lgkmcnt(0)
    v_xor_b32 v174, v8, v174
    v_bitop3_b32 v173, v8, v173, v174 bitop3:0xbe
    v_bitop3_b32 v172, v8, v172, v173 bitop3:0xbe
    v_bitop3_b32 v171, v8, v171, v172 bitop3:0xbe
    v_bitop3_b32 v170, v8, v170, v171 bitop3:0xbe
    v_bitop3_b32 v169, v8, v169, v170 bitop3:0xbe
    v_bitop3_b32 v168, v8, v168, v169 bitop3:0xbe
    v_cmp_lt_u32 vcc, 0xffff, v168
    s_nop 0
    s_cmp_eq_u64 vcc, 0
    s_cbranch_scc1 L_m_rb_20
    s_add_u32 s34, s34, 1
    s_cmp_lt_u32 s34, 262144
    s_cbranch_scc1 L_m_rl_90
    s_branch L_m_rb_20
L_m_md_25:
    v_pk_mul_f32 v[144:145], v[144:145], v[12:13] op_sel_hi:[1,0]
    v_pk_mul_f32 v[146:147], v[146:147], v[12:13] op_sel_hi:[1,0]
    v_pk_mul_f32 v[148:149], v[148:149], v[12:13] op_sel_hi:[1,0]
    v_pk_mul_f32 v[150:151], v[150:151], v[12:13] op_sel_hi:[1,0]
    v_cvt_pk_bf16_f32 v192, v144, v145
    v_cvt_pk_bf16_f32 v193, v146, v147
    v_cvt_pk_bf16_f32 v194, v148, v149
    v_cvt_pk_bf16_f32 v195, v150, v151
    v_and_or_b32 v195, v195, s17, v13
    buffer_store_dwordx4 v[192:195], v2, s[4:7], s16 offen offset:0 sc1
    v_pk_mul_f32 v[152:153], v[152:153], v[12:13] op_sel_hi:[1,0]
    v_pk_mul_f32 v[154:155], v[154:155], v[12:13] op_sel_hi:[1,0]
    v_pk_mul_f32 v[156:157], v[156:157], v[12:13] op_sel_hi:[1,0]
    v_pk_mul_f32 v[158:159], v[158:159], v[12:13] op_sel_hi:[1,0]
    v_cvt_pk_bf16_f32 v196, v152, v153
    v_cvt_pk_bf16_f32 v197, v154, v155
    v_cvt_pk_bf16_f32 v198, v156, v157
    v_cvt_pk_bf16_f32 v199, v158, v159
    v_and_or_b32 v199, v199, s17, v13
    buffer_store_dwordx4 v[196:199], v2, s[4:7], s16 offen offset:1024 sc1
    s_branch L_m_md_26
L_m_rs_33:
    s_mov_b32 s34, 0
L_m_rl_91:
    s_sleep 1
    s_add_u32 s12, s13, 4096
    buffer_load_dwordx4 v[32:35], v2, s[4:7], s12 offen offset:0 sc1
    buffer_load_dwordx4 v[36:39], v2, s[4:7], s12 offen offset:1024 sc1
    buffer_load_dwordx4 v[40:43], v2, s[4:7], s12 offen offset:2048 sc1
    buffer_load_dwordx4 v[44:47], v2, s[4:7], s12 offen offset:3072 sc1
    s_waitcnt vmcnt(0)
    v_xor_b32 v8, v13, v47
    v_bitop3_b32 v8, v13, v35, v8 bitop3:0xbe
    v_bitop3_b32 v8, v13, v39, v8 bitop3:0xbe
    v_bitop3_b32 v8, v13, v43, v8 bitop3:0xbe
    v_cmp_lt_u32 vcc, s17, v8
    s_nop 0
    s_cmp_eq_u64 vcc, 0
    s_cbranch_scc1 L_m_ro_92
    s_add_u32 s34, s34, 1
    s_cmp_lt_u32 s34, 262144
    s_cbranch_scc1 L_m_rl_91
L_m_ro_92:
    s_add_u32 s12, s13, 8192
    buffer_load_dwordx4 v[48:51], v2, s[4:7], s12 offen offset:0 sc1
    buffer_load_dwordx4 v[52:55], v2, s[4:7], s12 offen offset:1024 sc1
    buffer_load_dwordx4 v[56:59], v2, s[4:7], s12 offen offset:2048 sc1
    buffer_load_dwordx4 v[60:63], v2, s[4:7], s12 offen offset:3072 sc1
    s_add_u32 s12, s13, 12288
    buffer_load_dwordx4 v[64:67], v2, s[4:7], s12 offen offset:0 sc1
    buffer_load_dwordx4 v[68:71], v2, s[4:7], s12 offen offset:1024 sc1
    s_branch L_m_rb_34
L_m_rs_35:
    s_mov_b32 s34, 0
L_m_rl_93:
    s_sleep 1
    s_add_u32 s12, s13, 8192
    buffer_load_dwordx4 v[48:51], v2, s[4:7], s12 offen offset:0 sc1
    buffer_load_dwordx4 v[52:55], v2, s[4:7], s12 offen offset:1024 sc1
    buffer_load_dwordx4 v[56:59], v2, s[4:7], s12 offen offset:2048 sc1
    buffer_load_dwordx4 v[60:63], v2, s[4:7], s12 offen offset:3072 sc1
    s_waitcnt vmcnt(0)
    v_xor_b32 v8, v13, v63
    v_bitop3_b32 v8, v13, v51, v8 bitop3:0xbe
    v_bitop3_b32 v8, v13, v55, v8 bitop3:0xbe
    v_bitop3_b32 v8, v13, v59, v8 bitop3:0xbe
    v_cmp_lt_u32 vcc, s17, v8
    s_nop 0
    s_cmp_eq_u64 vcc, 0
    s_cbranch_scc1 L_m_ro_94
    s_add_u32 s34, s34, 1
    s_cmp_lt_u32 s34, 262144
    s_cbranch_scc1 L_m_rl_93
L_m_ro_94:
    s_add_u32 s12, s13, 12288
    buffer_load_dwordx4 v[64:67], v2, s[4:7], s12 offen offset:0 sc1
    buffer_load_dwordx4 v[68:71], v2, s[4:7], s12 offen offset:1024 sc1
    buffer_load_dwordx4 v[72:75], v2, s[4:7], s12 offen offset:2048 sc1
    buffer_load_dwordx4 v[76:79], v2, s[4:7], s12 offen offset:3072 sc1
    s_add_u32 s12, s13, 16384
    buffer_load_dwordx4 v[80:83], v2, s[4:7], s12 offen offset:0 sc1
    buffer_load_dwordx4 v[84:87], v2, s[4:7], s12 offen offset:1024 sc1
    s_branch L_m_rb_36
L_m_rs_37:
    s_mov_b32 s34, 0
L_m_rl_95:
    s_sleep 1
    s_add_u32 s12, s13, 12288
    buffer_load_dwordx4 v[64:67], v2, s[4:7], s12 offen offset:0 sc1
    buffer_load_dwordx4 v[68:71], v2, s[4:7], s12 offen offset:1024 sc1
    buffer_load_dwordx4 v[72:75], v2, s[4:7], s12 offen offset:2048 sc1
    buffer_load_dwordx4 v[76:79], v2, s[4:7], s12 offen offset:3072 sc1
    s_waitcnt vmcnt(0)
    v_xor_b32 v8, v13, v79
    v_bitop3_b32 v8, v13, v67, v8 bitop3:0xbe
    v_bitop3_b32 v8, v13, v71, v8 bitop3:0xbe
    v_bitop3_b32 v8, v13, v75, v8 bitop3:0xbe
    v_cmp_lt_u32 vcc, s17, v8
    s_nop 0
    s_cmp_eq_u64 vcc, 0
    s_cbranch_scc1 L_m_ro_96
    s_add_u32 s34, s34, 1
    s_cmp_lt_u32 s34, 262144
    s_cbranch_scc1 L_m_rl_95
L_m_ro_96:
    s_add_u32 s12, s13, 16384
    buffer_load_dwordx4 v[80:83], v2, s[4:7], s12 offen offset:0 sc1
    buffer_load_dwordx4 v[84:87], v2, s[4:7], s12 offen offset:1024 sc1
    buffer_load_dwordx4 v[88:91], v2, s[4:7], s12 offen offset:2048 sc1
    buffer_load_dwordx4 v[92:95], v2, s[4:7], s12 offen offset:3072 sc1
    s_add_u32 s12, s13, 20480
    buffer_load_dwordx4 v[96:99], v2, s[4:7], s12 offen offset:0 sc1
    buffer_load_dwordx4 v[100:103], v2, s[4:7], s12 offen offset:1024 sc1
    s_branch L_m_rb_38
L_m_rs_39:
    s_mov_b32 s34, 0
L_m_rl_97:
    s_sleep 1
    s_add_u32 s12, s13, 16384
    buffer_load_dwordx4 v[80:83], v2, s[4:7], s12 offen offset:0 sc1
    buffer_load_dwordx4 v[84:87], v2, s[4:7], s12 offen offset:1024 sc1
    buffer_load_dwordx4 v[88:91], v2, s[4:7], s12 offen offset:2048 sc1
    buffer_load_dwordx4 v[92:95], v2, s[4:7], s12 offen offset:3072 sc1
    s_waitcnt vmcnt(0)
    v_xor_b32 v8, v13, v95
    v_bitop3_b32 v8, v13, v83, v8 bitop3:0xbe
    v_bitop3_b32 v8, v13, v87, v8 bitop3:0xbe
    v_bitop3_b32 v8, v13, v91, v8 bitop3:0xbe
    v_cmp_lt_u32 vcc, s17, v8
    s_nop 0
    s_cmp_eq_u64 vcc, 0
    s_cbranch_scc1 L_m_ro_98
    s_add_u32 s34, s34, 1
    s_cmp_lt_u32 s34, 262144
    s_cbranch_scc1 L_m_rl_97
L_m_ro_98:
    s_add_u32 s12, s13, 20480
    buffer_load_dwordx4 v[96:99], v2, s[4:7], s12 offen offset:0 sc1
    buffer_load_dwordx4 v[100:103], v2, s[4:7], s12 offen offset:1024 sc1
    buffer_load_dwordx4 v[104:107], v2, s[4:7], s12 offen offset:2048 sc1
    buffer_load_dwordx4 v[108:111], v2, s[4:7], s12 offen offset:3072 sc1
    s_add_u32 s12, s13, 24576
    buffer_load_dwordx4 v[112:115], v2, s[4:7], s12 offen offset:0 sc1
    buffer_load_dwordx4 v[116:119], v2, s[4:7], s12 offen offset:1024 sc1
    s_branch L_m_rb_40
L_m_rs_41:
    s_mov_b32 s34, 0
L_m_rl_99:
    s_sleep 1
    s_add_u32 s12, s13, 20480
    buffer_load_dwordx4 v[96:99], v2, s[4:7], s12 offen offset:0 sc1
    buffer_load_dwordx4 v[100:103], v2, s[4:7], s12 offen offset:1024 sc1
    buffer_load_dwordx4 v[104:107], v2, s[4:7], s12 offen offset:2048 sc1
    buffer_load_dwordx4 v[108:111], v2, s[4:7], s12 offen offset:3072 sc1
    s_waitcnt vmcnt(0)
    v_xor_b32 v8, v13, v111
    v_bitop3_b32 v8, v13, v99, v8 bitop3:0xbe
    v_bitop3_b32 v8, v13, v103, v8 bitop3:0xbe
    v_bitop3_b32 v8, v13, v107, v8 bitop3:0xbe
    v_cmp_lt_u32 vcc, s17, v8
    s_nop 0
    s_cmp_eq_u64 vcc, 0
    s_cbranch_scc1 L_m_ro_100
    s_add_u32 s34, s34, 1
    s_cmp_lt_u32 s34, 262144
    s_cbranch_scc1 L_m_rl_99
L_m_ro_100:
    s_add_u32 s12, s13, 24576
    buffer_load_dwordx4 v[112:115], v2, s[4:7], s12 offen offset:0 sc1
    buffer_load_dwordx4 v[116:119], v2, s[4:7], s12 offen offset:1024 sc1
    buffer_load_dwordx4 v[120:123], v2, s[4:7], s12 offen offset:2048 sc1
    buffer_load_dwordx4 v[124:127], v2, s[4:7], s12 offen offset:3072 sc1
    s_add_u32 s12, s13, 28672
    buffer_load_dwordx4 v[128:131], v2, s[4:7], s12 offen offset:0 sc1
    s_branch L_m_rb_42
L_m_rs_43:
    s_mov_b32 s34, 0
L_m_rl_101:
    s_sleep 1
    s_add_u32 s12, s13, 24576
    buffer_load_dwordx4 v[112:115], v2, s[4:7], s12 offen offset:0 sc1
    buffer_load_dwordx4 v[116:119], v2, s[4:7], s12 offen offset:1024 sc1
    buffer_load_dwordx4 v[120:123], v2, s[4:7], s12 offen offset:2048 sc1
    buffer_load_dwordx4 v[124:127], v2, s[4:7], s12 offen offset:3072 sc1
    s_waitcnt vmcnt(0)
    v_xor_b32 v8, v13, v127
    v_bitop3_b32 v8, v13, v115, v8 bitop3:0xbe
    v_bitop3_b32 v8, v13, v119, v8 bitop3:0xbe
    v_bitop3_b32 v8, v13, v123, v8 bitop3:0xbe
    v_cmp_lt_u32 vcc, s17, v8
    s_nop 0
    s_cmp_eq_u64 vcc, 0
    s_cbranch_scc1 L_m_ro_102
    s_add_u32 s34, s34, 1
    s_cmp_lt_u32 s34, 262144
    s_cbranch_scc1 L_m_rl_101
L_m_ro_102:
    s_add_u32 s12, s13, 28672
    buffer_load_dwordx4 v[128:131], v2, s[4:7], s12 offen offset:0 sc1
    buffer_load_dwordx4 v[132:135], v2, s[4:7], s12 offen offset:1024 sc1
    buffer_load_dwordx4 v[136:139], v2, s[4:7], s12 offen offset:2048 sc1
    buffer_load_dwordx4 v[140:143], v2, s[4:7], s12 offen offset:3072 sc1
    s_branch L_m_rb_44
L_m_rs_45:
    s_mov_b32 s34, 0
L_m_rl_103:
    s_sleep 1
    s_add_u32 s12, s13, 28672
    buffer_load_dwordx4 v[128:131], v2, s[4:7], s12 offen offset:0 sc1
    buffer_load_dwordx4 v[132:135], v2, s[4:7], s12 offen offset:1024 sc1
    buffer_load_dwordx4 v[136:139], v2, s[4:7], s12 offen offset:2048 sc1
    buffer_load_dwordx4 v[140:143], v2, s[4:7], s12 offen offset:3072 sc1
    s_waitcnt vmcnt(0)
    v_xor_b32 v8, v13, v143
    v_bitop3_b32 v8, v13, v131, v8 bitop3:0xbe
    v_bitop3_b32 v8, v13, v135, v8 bitop3:0xbe
    v_bitop3_b32 v8, v13, v139, v8 bitop3:0xbe
    v_cmp_lt_u32 vcc, s17, v8
    s_nop 0
    s_cmp_eq_u64 vcc, 0
    s_cbranch_scc1 L_m_ro_104
    s_add_u32 s34, s34, 1
    s_cmp_lt_u32 s34, 262144
    s_cbranch_scc1 L_m_rl_103
L_m_ro_104:
    s_branch L_m_rb_46
L_m_md_47:
    buffer_store_dword v192, v7, s[4:7], s55 offen sc1
    s_branch L_m_md_48
L_m_md_55:
    buffer_store_dwordx4 v[240:243], v9, s[4:7], s44 offen offset:0 sc1
    buffer_store_dwordx4 v[244:247], v9, s[4:7], s44 offen offset:512 sc1
    v_pk_add_f32 v[192:193], v[160:161], v[162:163]
    v_pk_mul_f32 v[194:195], v[160:161], v[160:161]
    v_pk_fma_f32 v[194:195], v[162:163], v[162:163], v[194:195]
    v_pk_add_f32 v[192:193], v[192:193], v[164:165]
    v_pk_fma_f32 v[194:195], v[164:165], v[164:165], v[194:195]
    v_pk_add_f32 v[192:193], v[192:193], v[166:167]
    v_pk_fma_f32 v[194:195], v[166:167], v[166:167], v[194:195]
    v_pk_add_f32 v[192:193], v[192:193], v[168:169]
    v_pk_fma_f32 v[194:195], v[168:169], v[168:169], v[194:195]
    v_pk_add_f32 v[192:193], v[192:193], v[170:171]
    v_pk_fma_f32 v[194:195], v[170:171], v[170:171], v[194:195]
    v_pk_add_f32 v[192:193], v[192:193], v[172:173]
    v_pk_fma_f32 v[194:195], v[172:173], v[172:173], v[194:195]
    v_pk_add_f32 v[192:193], v[192:193], v[174:175]
    v_pk_fma_f32 v[194:195], v[174:175], v[174:175], v[194:195]
    v_add_f32 v192, v192, v193
    v_add_f32 v194, v194, v195
    s_nop 1
    v_permlane32_swap_b32 v192, v194
    v_add_f32 v192, v192, v194
    buffer_store_dword v192, v7, s[4:7], s53 offen sc1
    s_branch L_m_md_56
L_m_rs_61:
    s_mov_b32 s34, 0
L_m_rl_105:
    s_sleep 1
    s_add_u32 s12, s13, 4096
    buffer_load_dwordx4 v[32:35], v2, s[4:7], s12 offen offset:0 sc1
    buffer_load_dwordx4 v[36:39], v2, s[4:7], s12 offen offset:1024 sc1
    buffer_load_dwordx4 v[40:43], v2, s[4:7], s12 offen offset:2048 sc1
    buffer_load_dwordx4 v[44:47], v2, s[4:7], s12 offen offset:3072 sc1
    s_waitcnt vmcnt(0)
    v_max3_u32 v8, v47, v39, v43
    v_max_u32 v8, v8, v35
    v_cmp_eq_u32 vcc, -1, v8
    s_nop 0
    s_cmp_eq_u64 vcc, 0
    s_cbranch_scc1 L_m_ro_106
    s_add_u32 s34, s34, 1
    s_cmp_lt_u32 s34, 262144
    s_cbranch_scc1 L_m_rl_105
L_m_ro_106:
    s_add_u32 s12, s13, 8192
    buffer_load_dwordx4 v[48:51], v2, s[4:7], s12 offen offset:0 sc1
    buffer_load_dwordx4 v[52:55], v2, s[4:7], s12 offen offset:1024 sc1
    buffer_load_dwordx4 v[56:59], v2, s[4:7], s12 offen offset:2048 sc1
    buffer_load_dwordx4 v[60:63], v2, s[4:7], s12 offen offset:3072 sc1
    s_add_u32 s12, s13, 12288
    buffer_load_dwordx4 v[64:67], v2, s[4:7], s12 offen offset:0 sc1
    buffer_load_dwordx4 v[68:71], v2, s[4:7], s12 offen offset:1024 sc1
    s_branch L_m_rb_62
L_m_rs_63:
    s_mov_b32 s34, 0
L_m_rl_107:
    s_sleep 1
    s_add_u32 s12, s13, 8192
    buffer_load_dwordx4 v[48:51], v2, s[4:7], s12 offen offset:0 sc1
    buffer_load_dwordx4 v[52:55], v2, s[4:7], s12 offen offset:1024 sc1
    buffer_load_dwordx4 v[56:59], v2, s[4:7], s12 offen offset:2048 sc1
    buffer_load_dwordx4 v[60:63], v2, s[4:7], s12 offen offset:3072 sc1
    s_waitcnt vmcnt(0)
    v_max3_u32 v8, v63, v55, v59
    v_max_u32 v8, v8, v51
    v_cmp_eq_u32 vcc, -1, v8
    s_nop 0
    s_cmp_eq_u64 vcc, 0
    s_cbranch_scc1 L_m_ro_108
    s_add_u32 s34, s34, 1
    s_cmp_lt_u32 s34, 262144
    s_cbranch_scc1 L_m_rl_107
L_m_ro_108:
    s_add_u32 s12, s13, 12288
    buffer_load_dwordx4 v[64:67], v2, s[4:7], s12 offen offset:0 sc1
    buffer_load_dwordx4 v[68:71], v2, s[4:7], s12 offen offset:1024 sc1
    buffer_load_dwordx4 v[72:75], v2, s[4:7], s12 offen offset:2048 sc1
    buffer_load_dwordx4 v[76:79], v2, s[4:7], s12 offen offset:3072 sc1
    s_add_u32 s12, s13, 16384
    buffer_load_dwordx4 v[80:83], v2, s[4:7], s12 offen offset:0 sc1
    buffer_load_dwordx4 v[84:87], v2, s[4:7], s12 offen offset:1024 sc1
    s_branch L_m_rb_64
L_m_rs_65:
    s_mov_b32 s34, 0
L_m_rl_109:
    s_sleep 1
    s_add_u32 s12, s13, 12288
    buffer_load_dwordx4 v[64:67], v2, s[4:7], s12 offen offset:0 sc1
    buffer_load_dwordx4 v[68:71], v2, s[4:7], s12 offen offset:1024 sc1
    buffer_load_dwordx4 v[72:75], v2, s[4:7], s12 offen offset:2048 sc1
    buffer_load_dwordx4 v[76:79], v2, s[4:7], s12 offen offset:3072 sc1
    s_waitcnt vmcnt(0)
    v_max3_u32 v8, v79, v71, v75
    v_max_u32 v8, v8, v67
    v_cmp_eq_u32 vcc, -1, v8
    s_nop 0
    s_cmp_eq_u64 vcc, 0
    s_cbranch_scc1 L_m_ro_110
    s_add_u32 s34, s34, 1
    s_cmp_lt_u32 s34, 262144
    s_cbranch_scc1 L_m_rl_109
L_m_ro_110:
    s_add_u32 s12, s13, 16384
    buffer_load_dwordx4 v[80:83], v2, s[4:7], s12 offen offset:0 sc1
    buffer_load_dwordx4 v[84:87], v2, s[4:7], s12 offen offset:1024 sc1
    buffer_load_dwordx4 v[88:91], v2, s[4:7], s12 offen offset:2048 sc1
    buffer_load_dwordx4 v[92:95], v2, s[4:7], s12 offen offset:3072 sc1
    s_add_u32 s12, s13, 20480
    buffer_load_dwordx4 v[96:99], v2, s[4:7], s12 offen offset:0 sc1
    buffer_load_dwordx4 v[100:103], v2, s[4:7], s12 offen offset:1024 sc1
    s_branch L_m_rb_66
L_m_rs_67:
    s_mov_b32 s34, 0
L_m_rl_111:
    s_sleep 1
    s_add_u32 s12, s13, 16384
    buffer_load_dwordx4 v[80:83], v2, s[4:7], s12 offen offset:0 sc1
    buffer_load_dwordx4 v[84:87], v2, s[4:7], s12 offen offset:1024 sc1
    buffer_load_dwordx4 v[88:91], v2, s[4:7], s12 offen offset:2048 sc1
    buffer_load_dwordx4 v[92:95], v2, s[4:7], s12 offen offset:3072 sc1
    s_waitcnt vmcnt(0)
    v_max3_u32 v8, v95, v87, v91
    v_max_u32 v8, v8, v83
    v_cmp_eq_u32 vcc, -1, v8
    s_nop 0
    s_cmp_eq_u64 vcc, 0
    s_cbranch_scc1 L_m_ro_112
    s_add_u32 s34, s34, 1
    s_cmp_lt_u32 s34, 262144
    s_cbranch_scc1 L_m_rl_111
L_m_ro_112:
    s_add_u32 s12, s13, 20480
    buffer_load_dwordx4 v[96:99], v2, s[4:7], s12 offen offset:0 sc1
    buffer_load_dwordx4 v[100:103], v2, s[4:7], s12 offen offset:1024 sc1
    buffer_load_dwordx4 v[104:107], v2, s[4:7], s12 offen offset:2048 sc1
    buffer_load_dwordx4 v[108:111], v2, s[4:7], s12 offen offset:3072 sc1
    s_add_u32 s12, s13, 24576
    buffer_load_dwordx4 v[112:115], v2, s[4:7], s12 offen offset:0 sc1
    buffer_load_dwordx4 v[116:119], v2, s[4:7], s12 offen offset:1024 sc1
    s_branch L_m_rb_68
L_m_rs_69:
    s_mov_b32 s34, 0
L_m_rl_113:
    s_sleep 1
    s_add_u32 s12, s13, 20480
    buffer_load_dwordx4 v[96:99], v2, s[4:7], s12 offen offset:0 sc1
    buffer_load_dwordx4 v[100:103], v2, s[4:7], s12 offen offset:1024 sc1
    buffer_load_dwordx4 v[104:107], v2, s[4:7], s12 offen offset:2048 sc1
    buffer_load_dwordx4 v[108:111], v2, s[4:7], s12 offen offset:3072 sc1
    s_waitcnt vmcnt(0)
    v_max3_u32 v8, v111, v103, v107
    v_max_u32 v8, v8, v99
    v_cmp_eq_u32 vcc, -1, v8
    s_nop 0
    s_cmp_eq_u64 vcc, 0
    s_cbranch_scc1 L_m_ro_114
    s_add_u32 s34, s34, 1
    s_cmp_lt_u32 s34, 262144
    s_cbranch_scc1 L_m_rl_113
L_m_ro_114:
    s_add_u32 s12, s13, 24576
    buffer_load_dwordx4 v[112:115], v2, s[4:7], s12 offen offset:0 sc1
    buffer_load_dwordx4 v[116:119], v2, s[4:7], s12 offen offset:1024 sc1
    buffer_load_dwordx4 v[120:123], v2, s[4:7], s12 offen offset:2048 sc1
    buffer_load_dwordx4 v[124:127], v2, s[4:7], s12 offen offset:3072 sc1
    buffer_load_dwordx4 v[200:203], v2, s[4:7], s54 offen offset:0 sc1
    buffer_load_dwordx4 v[204:207], v2, s[4:7], s54 offen offset:1024 sc1
    s_branch L_m_rb_70
L_m_rs_71:
    s_mov_b32 s34, 0
L_m_rl_115:
    s_sleep 1
    s_add_u32 s12, s13, 24576
    buffer_load_dwordx4 v[112:115], v2, s[4:7], s12 offen offset:0 sc1
    buffer_load_dwordx4 v[116:119], v2, s[4:7], s12 offen offset:1024 sc1
    buffer_load_dwordx4 v[120:123], v2, s[4:7], s12 offen offset:2048 sc1
    buffer_load_dwordx4 v[124:127], v2, s[4:7], s12 offen offset:3072 sc1
    s_waitcnt vmcnt(0)
    v_max3_u32 v8, v127, v119, v123
    v_max_u32 v8, v8, v115
    v_cmp_eq_u32 vcc, -1, v8
    s_nop 0
    s_cmp_eq_u64 vcc, 0
    s_cbranch_scc1 L_m_ro_116
    s_add_u32 s34, s34, 1
    s_cmp_lt_u32 s34, 262144
    s_cbranch_scc1 L_m_rl_115
L_m_ro_116:
    buffer_load_dwordx4 v[200:203], v2, s[4:7], s54 offen offset:0 sc1
    buffer_load_dwordx4 v[204:207], v2, s[4:7], s54 offen offset:1024 sc1
    buffer_load_dwordx4 v[208:211], v2, s[4:7], s54 offen offset:2048 sc1
    buffer_load_dwordx4 v[212:215], v2, s[4:7], s54 offen offset:3072 sc1
    s_branch L_m_rb_72
L_m_wbl_75:
    s_endpgm
L_m_md_78:
    buffer_store_dword v6, v7, s[4:7], s53 offen sc1
    s_branch L_m_md_79
L_codeend:
.section .rodata,"a"
.p2align 6
.amdhsa_kernel interleave_layers__linear_kernel_hedgehog__spectral_fnet__prompt_kernel
  .amdhsa_next_free_vgpr 440
  .amdhsa_next_free_sgpr 102
  .amdhsa_accum_offset 256
  .amdhsa_group_segment_fixed_size 0
  .amdhsa_kernarg_size 96
  .amdhsa_user_sgpr_count 2
  .amdhsa_user_sgpr_kernarg_segment_ptr 1
  .amdhsa_system_sgpr_workgroup_id_x 1
.end_amdhsa_kernel
```
